```python
import torch

def _softmax(x, axis=-1):
    return torch.softmax(x, dim=axis)
def _gelu(x):
    return torch.nn.functional.gelu(x, approximate="tanh")
def _silu(x):
    return torch.nn.functional.silu(x)
def _sigmoid(x):
    return torch.sigmoid(x)
def _layernorm(x, axis=-1, eps=1e-5):
    m = x.mean(dim=axis, keepdim=True)
    v = x.var(dim=axis, keepdim=True, unbiased=False)
    return (x - m) / torch.sqrt(v + eps)
def _scatter_add(tgt, idx, src, axis=0):
    return tgt.clone().index_add_(axis, idx, src)
def _segment_sum(src, seg, n):
    out = torch.zeros((n,) + src.shape[1:], dtype=src.dtype)
    return out.index_add_(0, seg, src)
def _pad(x, pw):
    flat = tuple(v for pair in reversed(pw) for v in pair)
    return torch.nn.functional.pad(x, flat)

kernel_name = 'standalone__edge_featured_mpnn_mpnn__graph'

def setup_inputs():

    _w = (lambda a: (lambda t: t.to(torch.bfloat16) if t.is_floating_point() else t)(torch.as_tensor(a)))
    N, deg, D, De = 10000, 16, 128, max(0, 1)
    E = N * deg
    H = 2 * D
    return {
        "x": _w((lambda *s: torch.randn(*s, dtype=torch.bfloat16) * 0.05)(N, D)),
        "e_attr": _w((lambda *s: torch.randn(*s, dtype=torch.bfloat16) * 1.6)(E, De)),
        "src": _w((lambda lo, hi, *s: torch.randint(lo, hi, s))(0, N, E).to(torch.int64)),
        "dst": _w((lambda lo, hi, *s: torch.randint(lo, hi, s))(0, N, E).to(torch.int64)),
        "w1": _w((lambda *s: torch.randn(*s, dtype=torch.bfloat16) * 1.6)(2 * D + De, H) * (1.0 / (2 * D + De) ** 0.5)),
        "b1": _w((lambda *s: torch.randn(*s, dtype=torch.bfloat16) * 1.6)(H) * 0.01),
        "w2": _w((lambda *s: torch.randn(*s, dtype=torch.bfloat16) * 0.05)(H, D) * (1.0 / H ** 0.5)),
        "b2": _w((lambda *s: torch.randn(*s, dtype=torch.bfloat16) * 0.05)(D) * 0.01),
    }

def reference(x, e_attr, src, dst, w1, b1, w2, b2):
    N, D = x.shape
    h_src = x[src]
    h_dst = x[dst]
    m_in = torch.concatenate([h_src, h_dst, e_attr], axis=-1)
    h = _silu(m_in @ w1 + b1)
    msg = h @ w2 + b2
    return _segment_sum(msg, dst, N)
```

```asm
; @launch grid=(250,1,1) block=(1024,1,1) lds=163456
.amdgcn_target "amdgcn-amd-amdhsa--gfx950"
.text
.globl standalone__edge_featured_mpnn_mpnn__graph_kernel
.p2align 8
.type standalone__edge_featured_mpnn_mpnn__graph_kernel,@function
standalone__edge_featured_mpnn_mpnn__graph_kernel:
    s_load_dwordx16 s[4:19], s[0:1], 0
    s_load_dwordx4 s[20:23], s[0:1], 64
    s_load_dwordx2 s[24:25], s[0:1], 80
    s_memrealtime s[26:27]
    s_getpc_b64 s[40:41]
K_PC0:
    v_lshlrev_b32 v126, 7, v0
    s_and_b32 s41, s41, 0xffff
    s_mov_b32 s42, K_CODE_END-K_PC0
    s_mov_b32 s43, 0x20000
    buffer_load_dword v42, v126, s[40:43], 0 offen
    s_cmp_ge_u32 s2, 250
    s_cbranch_scc1 K_END
    v_and_b32 v1, 63, v0
    v_lshrrev_b32 v48, 6, v0
    v_lshlrev_b32 v6, 4, v0
    v_readfirstlane_b32 s3, v48
    v_lshlrev_b32 v2, 2, v1
    v_lshlrev_b32 v5, 4, v1
    v_and_b32 v36, 15, v1
    v_lshrrev_b32 v37, 4, v1
    v_mov_b32 v47, 0
    v_mov_b32 v46, 1
    v_mov_b32 v8, 0
    v_mov_b32 v9, 0
    v_mov_b32 v10, 0
    v_mov_b32 v11, 0
    s_movk_i32 s78, 280
    v_cmp_gt_u32 vcc, s78, v0
    s_mul_i32 s74, s2, 40
    s_lshr_b32 s55, s2, 1
    s_mul_i32 s55, s55, 80
    s_and_b32 s56, s2, 1
    s_and_saveexec_b64 s[76:77], vcc
    s_cbranch_execz K_Z1
    ds_write_b128 v6, v[8:11]
K_Z1:
    s_mov_b64 exec, s[76:77]
    s_mov_b32 s92, 0x05040100
    s_mov_b32 s93, 0x07060302
    s_mov_b32 s60, 0xbfb8aa3b
    s_mov_b32 s61, 0xbfb8aa3b
    s_mul_i32 s89, s3, 640
    s_add_u32 s89, s89, 4480
    v_add_u32 v30, s89, v2
    v_mov_b32 v31, 0x4b7ff000
    ds_write_b32 v30, v31
    ds_write_b32 v30, v31 offset:64
    s_cmp_lt_u32 s3, 8
    s_cbranch_scc1 K_AUX
    v_lshlrev_b32 v39, 12, v37
    v_lshl_add_u32 v39, v36, 4, v39
    s_and_b32 s78, s3, 3
    s_bfe_u32 s81, s3, 0x10002
    s_lshl_b32 s88, s78, 14
    s_lshl_b32 s79, s81, 11
    s_add_u32 s79, s79, s88
    s_lshl_b32 s80, s56, 8
    s_add_u32 s79, s79, s80
    s_lshl_b32 s80, s81, 8
    s_add_u32 s88, s88, s80
    s_add_u32 s88, s88, 65536
    s_waitcnt lgkmcnt(0)
    s_mov_b32 s44, s12
    s_and_b32 s45, s13, 0xffff
    s_mov_b32 s46, 0x20200
    s_mov_b32 s47, 0x20000
    buffer_load_dwordx4 v[64:67], v39, s[44:47], s79 offen offset:0
    buffer_load_dwordx4 v[68:71], v39, s[44:47], s79 offen offset:512
    buffer_load_dwordx4 v[72:75], v39, s[44:47], s79 offen offset:1024
    buffer_load_dwordx4 v[76:79], v39, s[44:47], s79 offen offset:1536
    s_barrier
    s_setprio 2
    s_mov_b32 s32, s24
    s_and_b32 s33, s25, 0xffff
    s_mov_b32 s34, 0x10000000
    s_mov_b32 s35, 0x20000
    s_lshl_b32 s85, s3, 10
    s_add_u32 s85, s85, 35840
    s_mov_b32 s62, 0
    s_sub_u32 s28, s24, 0x4b000000
    s_subb_u32 s29, s25, 0
    s_and_b32 s29, s29, 0xffff
    s_mov_b32 s30, 0x4b4e2000
    s_mov_b32 s31, 0x20000
    s_lshl_b32 s75, s2, 3
    s_add_u32 s75, s75, 0x680000
    v_cvt_f32_u32 v3, v2
    v_lshlrev_b32 v4, 3, v1
    v_add_u32 v4, 14720, v4
    v_add_u32 v7, 56320, v5
    v_cmp_gt_u32 s[90:91], 8, v36
    s_lshl_b32 s87, s74, 8
    s_lshl_b32 s80, s3, 5
    s_add_u32 s87, s87, s80
    s_mov_b32 s63, 1
    s_lshl_b32 s78, s78, 10
    s_add_u32 s78, s78, 97920
    s_lshl_b32 s79, s81, 3
    s_add_u32 s79, s79, s78
    v_add_u32 v12, s79, v5
    s_lshl_b32 s79, s81, 15
    s_add_u32 s79, s79, s78
    v_add_u32 v44, s79, v5
    v_xor_b32 v13, v37, v36
    v_lshlrev_b32 v13, 4, v13
    v_lshl_add_u32 v13, v36, 8, v13
    v_xor_b32 v8, 0, v13
    v_xor_b32 v9, 64, v13
    v_xor_b32 v10, 128, v13
    v_xor_b32 v11, 192, v13
    s_sub_u32 s78, s3, 8
    s_lshl_b32 s79, s78, 12
    s_add_u32 s79, s79, 97920
    v_add_u32 v40, s79, v5
    s_lshr_b32 s79, s78, 2
    s_lshl_b32 s79, s79, 4
    s_and_b32 s80, s78, 3
    s_add_u32 s79, s79, s80
    v_lshl_add_u32 v13, v37, 2, s79
    s_movk_i32 s79, 272
    v_lshlrev_b32 v41, 2, v13
    v_mad_u32_u24 v41, v36, s79, v41
    v_add_u32 v41, 56320, v41
    s_mov_b32 s80, 0x8000
    s_waitcnt vmcnt(0)
    v_perm_b32 v48, v68, v64, s92
    v_perm_b32 v50, v68, v64, s93
    v_perm_b32 v52, v69, v65, s92
    v_perm_b32 v54, v69, v65, s93
    v_perm_b32 v56, v70, v66, s92
    v_perm_b32 v58, v70, v66, s93
    v_perm_b32 v60, v71, v67, s92
    v_perm_b32 v62, v71, v67, s93
    v_perm_b32 v49, v76, v72, s92
    v_perm_b32 v51, v76, v72, s93
    v_perm_b32 v53, v77, v73, s92
    v_perm_b32 v55, v77, v73, s93
    v_perm_b32 v57, v78, v74, s92
    v_perm_b32 v59, v78, v74, s93
    v_perm_b32 v61, v79, v75, s92
    v_perm_b32 v63, v79, v75, s93
    ds_write_b64 v12, v[48:49] offset:0
    ds_write_b64 v12, v[50:51] offset:4096
    ds_write_b64 v12, v[52:53] offset:8192
    ds_write_b64 v12, v[54:55] offset:12288
    ds_write_b64 v12, v[56:57] offset:16384
    ds_write_b64 v12, v[58:59] offset:20480
    ds_write_b64 v12, v[60:61] offset:24576
    ds_write_b64 v12, v[62:63] offset:28672
    s_waitcnt lgkmcnt(0)
    s_mov_b64 exec, 1
    ds_add_u32 v47, v46 offset:864
    s_mov_b64 exec, -1
    buffer_load_dwordx4 v[96:99], v39, s[44:47], s88 offen offset:0
    buffer_load_dwordx4 v[100:103], v39, s[44:47], s88 offen offset:512
    buffer_load_dwordx4 v[104:107], v39, s[44:47], s88 offen offset:1024
    buffer_load_dwordx4 v[108:111], v39, s[44:47], s88 offen offset:1536
    buffer_load_dwordx4 v[112:115], v39, s[44:47], s88 offen offset:2048
    buffer_load_dwordx4 v[116:119], v39, s[44:47], s88 offen offset:2560
    buffer_load_dwordx4 v[120:123], v39, s[44:47], s88 offen offset:3072
    buffer_load_dwordx4 v[124:127], v39, s[44:47], s88 offen offset:3584
    s_mov_b32 s67, 1048576
K_AW1:
    ds_read_b32 v12, v47 offset:864
    s_waitcnt lgkmcnt(0)
    v_readfirstlane_b32 s78, v12
    s_cmp_ge_u32 s78, 13
    s_cbranch_scc1 K_AWD1
    s_sub_u32 s67, s67, 1
    s_cbranch_scc1 K_END
    s_sleep 1
    s_branch K_AW1
K_AWD1:
    ds_read_b128 v[48:51], v40 offset:0
    ds_read_b128 v[52:55], v40 offset:1024
    ds_read_b128 v[56:59], v40 offset:2048
    ds_read_b128 v[60:63], v40 offset:3072
    ds_read_b128 v[64:67], v8 offset:35840
    ds_read_b128 v[68:71], v9 offset:35840
    ds_read_b128 v[72:75], v10 offset:35840
    ds_read_b128 v[76:79], v11 offset:35840
    ds_read_b128 v[80:83], v8 offset:39936
    ds_read_b128 v[84:87], v9 offset:39936
    ds_read_b128 v[88:91], v10 offset:39936
    ds_read_b128 v[92:95], v11 offset:39936
    s_waitcnt lgkmcnt(7)
    v_mfma_f32_16x16x32_bf16 v[16:19], v[48:51], v[64:67], 0
    ds_read_b128 v[64:67], v8 offset:44032
    s_waitcnt lgkmcnt(7)
    v_mfma_f32_16x16x32_bf16 v[16:19], v[52:55], v[68:71], v[16:19]
    ds_read_b128 v[68:71], v9 offset:44032
    s_waitcnt lgkmcnt(7)
    v_mfma_f32_16x16x32_bf16 v[16:19], v[56:59], v[72:75], v[16:19]
    ds_read_b128 v[72:75], v10 offset:44032
    s_waitcnt lgkmcnt(7)
    v_mfma_f32_16x16x32_bf16 v[16:19], v[60:63], v[76:79], v[16:19]
    ds_read_b128 v[76:79], v11 offset:44032
    s_waitcnt lgkmcnt(7)
    v_mfma_f32_16x16x32_bf16 v[20:23], v[48:51], v[80:83], 0
    ds_read_b128 v[80:83], v8 offset:48128
    s_waitcnt lgkmcnt(7)
    v_mfma_f32_16x16x32_bf16 v[20:23], v[52:55], v[84:87], v[20:23]
    ds_read_b128 v[84:87], v9 offset:48128
    s_waitcnt lgkmcnt(7)
    v_mfma_f32_16x16x32_bf16 v[20:23], v[56:59], v[88:91], v[20:23]
    ds_read_b128 v[88:91], v10 offset:48128
    s_waitcnt lgkmcnt(7)
    v_mfma_f32_16x16x32_bf16 v[20:23], v[60:63], v[92:95], v[20:23]
    v_add_f32 v16, 0, v16
    v_add_f32 v17, 0, v17
    v_add_f32 v18, 0, v18
    v_add_f32 v19, 0, v19
    ds_read_b128 v[92:95], v11 offset:48128
    s_waitcnt lgkmcnt(7)
    v_mfma_f32_16x16x32_bf16 v[24:27], v[48:51], v[64:67], 0
    v_add_u32 v16, s80, v16
    v_add_u32 v17, s80, v17
    v_add_u32 v18, s80, v18
    v_add_u32 v19, s80, v19
    ds_read_b128 v[64:67], v8 offset:52224
    s_waitcnt lgkmcnt(7)
    v_mfma_f32_16x16x32_bf16 v[24:27], v[52:55], v[68:71], v[24:27]
    v_sub_u32_sdwa v17, v17, v16 clamp dst_sel:DWORD dst_unused:UNUSED_PAD src0_sel:DWORD src1_sel:WORD_1
    v_sub_u32_sdwa v18, v18, v17 clamp dst_sel:DWORD dst_unused:UNUSED_PAD src0_sel:DWORD src1_sel:WORD_1
    v_sub_u32_sdwa v19, v19, v18 clamp dst_sel:DWORD dst_unused:UNUSED_PAD src0_sel:DWORD src1_sel:WORD_1
    v_perm_b32 v16, v17, v16, s93
    ds_read_b128 v[68:71], v9 offset:52224
    s_waitcnt lgkmcnt(7)
    v_mfma_f32_16x16x32_bf16 v[24:27], v[56:59], v[72:75], v[24:27]
    v_perm_b32 v18, v19, v18, s93
    ds_read_b128 v[72:75], v10 offset:52224
    s_waitcnt lgkmcnt(7)
    v_mfma_f32_16x16x32_bf16 v[24:27], v[60:63], v[76:79], v[24:27]
    v_add_f32 v20, 0, v20
    v_add_f32 v21, 0, v21
    v_add_f32 v22, 0, v22
    v_add_f32 v23, 0, v23
    ds_read_b128 v[76:79], v11 offset:52224
    s_waitcnt lgkmcnt(7)
    v_mfma_f32_16x16x32_bf16 v[28:31], v[48:51], v[80:83], 0
    v_add_u32 v20, s80, v20
    v_add_u32 v21, s80, v21
    v_add_u32 v22, s80, v22
    v_add_u32 v23, s80, v23
    s_waitcnt lgkmcnt(6)
    v_mfma_f32_16x16x32_bf16 v[28:31], v[52:55], v[84:87], v[28:31]
    v_sub_u32_sdwa v21, v21, v20 clamp dst_sel:DWORD dst_unused:UNUSED_PAD src0_sel:DWORD src1_sel:WORD_1
    v_sub_u32_sdwa v22, v22, v21 clamp dst_sel:DWORD dst_unused:UNUSED_PAD src0_sel:DWORD src1_sel:WORD_1
    v_sub_u32_sdwa v23, v23, v22 clamp dst_sel:DWORD dst_unused:UNUSED_PAD src0_sel:DWORD src1_sel:WORD_1
    v_perm_b32 v20, v21, v20, s93
    s_waitcnt lgkmcnt(5)
    v_mfma_f32_16x16x32_bf16 v[28:31], v[56:59], v[88:91], v[28:31]
    v_perm_b32 v22, v23, v22, s93
    s_waitcnt lgkmcnt(4)
    v_mfma_f32_16x16x32_bf16 v[28:31], v[60:63], v[92:95], v[28:31]
    v_add_f32 v24, 0, v24
    v_add_f32 v25, 0, v25
    v_add_f32 v26, 0, v26
    v_add_f32 v27, 0, v27
    s_waitcnt lgkmcnt(3)
    v_mfma_f32_16x16x32_bf16 v[32:35], v[48:51], v[64:67], 0
    v_add_u32 v24, s80, v24
    v_add_u32 v25, s80, v25
    v_add_u32 v26, s80, v26
    v_add_u32 v27, s80, v27
    s_waitcnt lgkmcnt(2)
    v_mfma_f32_16x16x32_bf16 v[32:35], v[52:55], v[68:71], v[32:35]
    v_sub_u32_sdwa v25, v25, v24 clamp dst_sel:DWORD dst_unused:UNUSED_PAD src0_sel:DWORD src1_sel:WORD_1
    v_sub_u32_sdwa v26, v26, v25 clamp dst_sel:DWORD dst_unused:UNUSED_PAD src0_sel:DWORD src1_sel:WORD_1
    v_sub_u32_sdwa v27, v27, v26 clamp dst_sel:DWORD dst_unused:UNUSED_PAD src0_sel:DWORD src1_sel:WORD_1
    v_perm_b32 v24, v25, v24, s93
    s_waitcnt lgkmcnt(1)
    v_mfma_f32_16x16x32_bf16 v[32:35], v[56:59], v[72:75], v[32:35]
    v_perm_b32 v26, v27, v26, s93
    s_waitcnt lgkmcnt(0)
    v_mfma_f32_16x16x32_bf16 v[32:35], v[60:63], v[76:79], v[32:35]
    v_add_f32 v28, 0, v28
    v_add_f32 v29, 0, v29
    v_add_f32 v30, 0, v30
    v_add_f32 v31, 0, v31
    v_add_u32 v28, s80, v28
    v_add_u32 v29, s80, v29
    v_add_u32 v30, s80, v30
    v_add_u32 v31, s80, v31
    v_sub_u32_sdwa v29, v29, v28 clamp dst_sel:DWORD dst_unused:UNUSED_PAD src0_sel:DWORD src1_sel:WORD_1
    v_sub_u32_sdwa v30, v30, v29 clamp dst_sel:DWORD dst_unused:UNUSED_PAD src0_sel:DWORD src1_sel:WORD_1
    v_sub_u32_sdwa v31, v31, v30 clamp dst_sel:DWORD dst_unused:UNUSED_PAD src0_sel:DWORD src1_sel:WORD_1
    v_perm_b32 v28, v29, v28, s93
    v_perm_b32 v30, v31, v30, s93
    s_nop 1
    v_add_f32 v32, 0, v32
    v_add_f32 v33, 0, v33
    v_add_f32 v34, 0, v34
    v_add_f32 v35, 0, v35
    v_add_u32 v32, s80, v32
    v_add_u32 v33, s80, v33
    v_add_u32 v34, s80, v34
    v_add_u32 v35, s80, v35
    v_sub_u32_sdwa v33, v33, v32 clamp dst_sel:DWORD dst_unused:UNUSED_PAD src0_sel:DWORD src1_sel:WORD_1
    v_sub_u32_sdwa v34, v34, v33 clamp dst_sel:DWORD dst_unused:UNUSED_PAD src0_sel:DWORD src1_sel:WORD_1
    v_sub_u32_sdwa v35, v35, v34 clamp dst_sel:DWORD dst_unused:UNUSED_PAD src0_sel:DWORD src1_sel:WORD_1
    v_perm_b32 v32, v33, v32, s93
    v_perm_b32 v34, v35, v34, s93
    ds_write_b32 v41, v16 offset:0
    ds_write_b32 v41, v18 offset:128
    ds_write_b32 v41, v20 offset:4352
    ds_write_b32 v41, v22 offset:4480
    ds_write_b32 v41, v24 offset:8704
    ds_write_b32 v41, v26 offset:8832
    ds_write_b32 v41, v28 offset:13056
    ds_write_b32 v41, v30 offset:13184
    ds_write_b32 v41, v32 offset:17408
    ds_write_b32 v41, v34 offset:17536
    v_bfe_u32 v12, v0, 4, 4
    s_movk_i32 s79, 272
    v_lshlrev_b32 v13, 4, v36
    v_mad_u32_u24 v14, v12, s79, v13
    v_add_u32 v14, 56320, v14
    v_and_b32 v15, 0x70, v13
    v_lshl_add_u32 v15, v12, 9, v15
    v_and_b32 v13, 0x80, v13
    v_lshl_add_u32 v15, v13, 1, v15
    s_lshl_b32 s78, s55, 9
    s_lshl_b32 s79, s56, 7
    s_add_u32 s78, s78, s79
    s_waitcnt lgkmcnt(0)
    s_mov_b64 exec, 1
    ds_add_u32 v47, v46 offset:868
    s_mov_b64 exec, -1
    s_mov_b32 s67, 1048576
K_AW2:
    ds_read_b32 v12, v47 offset:868
    s_waitcnt lgkmcnt(0)
    v_readfirstlane_b32 s81, v12
    s_cmp_ge_u32 s81, 9
    s_cbranch_scc1 K_AWD2
    s_sub_u32 s67, s67, 1
    s_cbranch_scc1 K_END
    s_sleep 1
    s_branch K_AW2
K_AWD2:
    s_cmp_lt_u32 s3, 12
    s_cbranch_scc1 K_GW
    ds_read_b128 v[48:51], v14 offset:0
    ds_read_b128 v[52:55], v14 offset:4352
    ds_read_b128 v[56:59], v14 offset:8704
    ds_read_b128 v[60:63], v14 offset:13056
    ds_read_b128 v[64:67], v14 offset:17408
    s_waitcnt lgkmcnt(4)
    buffer_store_dwordx4 v[48:51], v15, s[32:35], s78 offen sc1
    s_add_u32 s78, s78, 8192
    s_waitcnt lgkmcnt(3)
    buffer_store_dwordx4 v[52:55], v15, s[32:35], s78 offen sc1
    s_add_u32 s78, s78, 8192
    s_waitcnt lgkmcnt(2)
    buffer_store_dwordx4 v[56:59], v15, s[32:35], s78 offen sc1
    s_add_u32 s78, s78, 8192
    s_waitcnt lgkmcnt(1)
    buffer_store_dwordx4 v[60:63], v15, s[32:35], s78 offen sc1
    s_add_u32 s78, s78, 8192
    s_waitcnt lgkmcnt(0)
    buffer_store_dwordx4 v[64:67], v15, s[32:35], s78 offen sc1
    s_add_u32 s78, s78, 8192
    s_waitcnt vmcnt(5)
    v_perm_b32 v16, v100, v96, s92
    v_perm_b32 v17, v108, v104, s92
    v_perm_b32 v18, v116, v112, s92
    v_perm_b32 v19, v124, v120, s92
    ds_write_b128 v44, v[16:19] offset:0
    v_perm_b32 v20, v100, v96, s93
    v_perm_b32 v21, v108, v104, s93
    v_perm_b32 v22, v116, v112, s93
    v_perm_b32 v23, v124, v120, s93
    ds_write_b128 v44, v[20:23] offset:4096
    v_perm_b32 v24, v101, v97, s92
    v_perm_b32 v25, v109, v105, s92
    v_perm_b32 v26, v117, v113, s92
    v_perm_b32 v27, v125, v121, s92
    ds_write_b128 v44, v[24:27] offset:8192
    v_perm_b32 v28, v101, v97, s93
    v_perm_b32 v29, v109, v105, s93
    v_perm_b32 v30, v117, v113, s93
    v_perm_b32 v31, v125, v121, s93
    ds_write_b128 v44, v[28:31] offset:12288
    v_perm_b32 v32, v102, v98, s92
    v_perm_b32 v33, v110, v106, s92
    v_perm_b32 v34, v118, v114, s92
    v_perm_b32 v35, v126, v122, s92
    ds_write_b128 v44, v[32:35] offset:16384
    v_perm_b32 v16, v102, v98, s93
    v_perm_b32 v17, v110, v106, s93
    v_perm_b32 v18, v118, v114, s93
    v_perm_b32 v19, v126, v122, s93
    ds_write_b128 v44, v[16:19] offset:20480
    v_perm_b32 v20, v103, v99, s92
    v_perm_b32 v21, v111, v107, s92
    v_perm_b32 v22, v119, v115, s92
    v_perm_b32 v23, v127, v123, s92
    ds_write_b128 v44, v[20:23] offset:24576
    v_perm_b32 v24, v103, v99, s93
    v_perm_b32 v25, v111, v107, s93
    v_perm_b32 v26, v119, v115, s93
    v_perm_b32 v27, v127, v123, s93
    ds_write_b128 v44, v[24:27] offset:28672
    s_waitcnt lgkmcnt(0)
    s_mov_b64 exec, 1
    ds_add_u32 v47, v46 offset:872
    s_mov_b64 exec, -1
    s_mov_b32 s67, 1048576
K_AW3:
    ds_read_b32 v14, v47 offset:892
    s_waitcnt lgkmcnt(0)
    v_readfirstlane_b32 s66, v14
    s_cmp_lg_u32 s66, 0
    s_cbranch_scc1 K_AWD3
    s_sub_u32 s67, s67, 1
    s_cbranch_scc1 K_END
    s_sleep 1
    s_branch K_AW3
K_AWD3:
    s_waitcnt vmcnt(0)
    s_mov_b64 exec, 1
    ds_add_rtn_u32 v15, v47, v46 offset:876
    s_lshl_b32 s78, s2, 4
    s_add_u32 s78, s78, 0x700000
    s_waitcnt lgkmcnt(0)
    v_readfirstlane_b32 s79, v15
    s_cmp_lg_u32 s79, 3
    s_cbranch_scc1 K_NOPF
    buffer_store_dword v14, v47, s[32:35], s78 offen sc1
K_NOPF:
    s_mov_b64 exec, -1
    s_branch K_GQ
K_GW:
    s_waitcnt vmcnt(0)
    v_perm_b32 v16, v100, v96, s92
    v_perm_b32 v17, v108, v104, s92
    v_perm_b32 v18, v116, v112, s92
    v_perm_b32 v19, v124, v120, s92
    ds_write_b128 v44, v[16:19] offset:0
    v_perm_b32 v20, v100, v96, s93
    v_perm_b32 v21, v108, v104, s93
    v_perm_b32 v22, v116, v112, s93
    v_perm_b32 v23, v124, v120, s93
    ds_write_b128 v44, v[20:23] offset:4096
    v_perm_b32 v24, v101, v97, s92
    v_perm_b32 v25, v109, v105, s92
    v_perm_b32 v26, v117, v113, s92
    v_perm_b32 v27, v125, v121, s92
    ds_write_b128 v44, v[24:27] offset:8192
    v_perm_b32 v28, v101, v97, s93
    v_perm_b32 v29, v109, v105, s93
    v_perm_b32 v30, v117, v113, s93
    v_perm_b32 v31, v125, v121, s93
    ds_write_b128 v44, v[28:31] offset:12288
    v_perm_b32 v32, v102, v98, s92
    v_perm_b32 v33, v110, v106, s92
    v_perm_b32 v34, v118, v114, s92
    v_perm_b32 v35, v126, v122, s92
    ds_write_b128 v44, v[32:35] offset:16384
    v_perm_b32 v16, v102, v98, s93
    v_perm_b32 v17, v110, v106, s93
    v_perm_b32 v18, v118, v114, s93
    v_perm_b32 v19, v126, v122, s93
    ds_write_b128 v44, v[16:19] offset:20480
    v_perm_b32 v20, v103, v99, s92
    v_perm_b32 v21, v111, v107, s92
    v_perm_b32 v22, v119, v115, s92
    v_perm_b32 v23, v127, v123, s92
    ds_write_b128 v44, v[20:23] offset:24576
    v_perm_b32 v24, v103, v99, s93
    v_perm_b32 v25, v111, v107, s93
    v_perm_b32 v26, v119, v115, s93
    v_perm_b32 v27, v127, v123, s93
    ds_write_b128 v44, v[24:27] offset:28672
    s_waitcnt lgkmcnt(0)
    s_mov_b64 exec, 1
    ds_add_u32 v47, v46 offset:872
    s_mov_b64 exec, -1
    s_mov_b32 s67, 1048576
K_AW4:
    ds_read_b32 v14, v47 offset:892
    s_waitcnt lgkmcnt(0)
    v_readfirstlane_b32 s66, v14
    s_cmp_lg_u32 s66, 0
    s_cbranch_scc1 K_AWD4
    s_sub_u32 s67, s67, 1
    s_cbranch_scc1 K_END
    s_sleep 1
    s_branch K_AW4
K_AWD4:
K_GQ:
    s_sub_u32 s78, s3, 8
    s_lshl_b32 s79, s78, 13
    s_add_u32 s79, s79, 97920
    v_add_u32 v40, s79, v5
    s_lshr_b32 s79, s78, 1
    s_lshl_b32 s79, s79, 4
    s_and_b32 s78, s78, 1
    s_lshl_b32 s78, s78, 1
    s_add_u32 s78, s78, s79
    v_lshl_add_u32 v12, v37, 2, s78
    v_lshlrev_b32 v43, 4, v12
    s_movk_i32 s79, 1040
    v_mad_u32_u24 v41, v36, s79, v43
    v_add_u32 v41, 56320, v41
    s_mul_i32 s78, s56, 40
    v_add_u32 v12, s78, v36
    v_xor_b32 v13, v37, v12
    v_and_b32 v13, 15, v13
    v_lshlrev_b32 v13, 4, v13
    v_lshl_add_u32 v13, v12, 8, v13
    v_xor_b32 v8, 0, v13
    v_xor_b32 v9, 64, v13
    v_xor_b32 v10, 128, v13
    v_xor_b32 v11, 192, v13
    ds_read_b128 v[48:51], v8 offset:35840
    ds_read_b128 v[64:67], v8 offset:39936
    ds_read_b128 v[80:83], v8 offset:44032
    ds_read_b128 v[52:55], v9 offset:35840
    ds_read_b128 v[68:71], v9 offset:39936
    ds_read_b128 v[84:87], v9 offset:44032
    ds_read_b128 v[56:59], v10 offset:35840
    ds_read_b128 v[72:75], v10 offset:39936
    ds_read_b128 v[88:91], v10 offset:44032
    ds_read_b128 v[60:63], v11 offset:35840
    ds_read_b128 v[76:79], v11 offset:39936
    ds_read_b128 v[92:95], v11 offset:44032
    s_mov_b32 s67, 1048576
K_AW5:
    ds_read_b32 v12, v47 offset:872
    s_waitcnt lgkmcnt(0)
    v_readfirstlane_b32 s78, v12
    s_cmp_ge_u32 s78, 12
    s_cbranch_scc1 K_AWD5
    s_sub_u32 s67, s67, 1
    s_cbranch_scc1 K_END
    s_sleep 1
    s_branch K_AW5
K_AWD5:
    ds_read_b128 v[8:11], v43 offset:1920
    ds_read_b128 v[12:15], v43 offset:1936
    ds_read_b128 v[96:99], v40 offset:0
    ds_read_b128 v[100:103], v40 offset:4096
    ds_read_b128 v[104:107], v40 offset:1024
    ds_read_b128 v[108:111], v40 offset:5120
    ds_read_b128 v[112:115], v40 offset:2048
    ds_read_b128 v[116:119], v40 offset:6144
    ds_read_b128 v[120:123], v40 offset:3072
    ds_read_b128 v[124:127], v40 offset:7168
    s_waitcnt lgkmcnt(7)
    v_mfma_f32_16x16x32_bf16 v[16:19], v[96:99], v[48:51], v[8:11]
    v_mfma_f32_16x16x32_bf16 v[20:23], v[96:99], v[64:67], v[8:11]
    v_mfma_f32_16x16x32_bf16 v[24:27], v[96:99], v[80:83], v[8:11]
    s_waitcnt lgkmcnt(6)
    v_mfma_f32_16x16x32_bf16 v[28:31], v[100:103], v[48:51], v[12:15]
    v_mfma_f32_16x16x32_bf16 v[32:35], v[100:103], v[64:67], v[12:15]
    v_mfma_f32_16x16x32_bf16 v[36:39], v[100:103], v[80:83], v[12:15]
    s_waitcnt lgkmcnt(5)
    v_mfma_f32_16x16x32_bf16 v[16:19], v[104:107], v[52:55], v[16:19]
    v_mfma_f32_16x16x32_bf16 v[20:23], v[104:107], v[68:71], v[20:23]
    v_mfma_f32_16x16x32_bf16 v[24:27], v[104:107], v[84:87], v[24:27]
    s_waitcnt lgkmcnt(4)
    v_mfma_f32_16x16x32_bf16 v[28:31], v[108:111], v[52:55], v[28:31]
    v_mfma_f32_16x16x32_bf16 v[32:35], v[108:111], v[68:71], v[32:35]
    v_mfma_f32_16x16x32_bf16 v[36:39], v[108:111], v[84:87], v[36:39]
    s_waitcnt lgkmcnt(3)
    v_mfma_f32_16x16x32_bf16 v[16:19], v[112:115], v[56:59], v[16:19]
    v_mfma_f32_16x16x32_bf16 v[20:23], v[112:115], v[72:75], v[20:23]
    v_mfma_f32_16x16x32_bf16 v[24:27], v[112:115], v[88:91], v[24:27]
    s_waitcnt lgkmcnt(2)
    v_mfma_f32_16x16x32_bf16 v[28:31], v[116:119], v[56:59], v[28:31]
    v_mfma_f32_16x16x32_bf16 v[32:35], v[116:119], v[72:75], v[32:35]
    v_mfma_f32_16x16x32_bf16 v[36:39], v[116:119], v[88:91], v[36:39]
    s_waitcnt lgkmcnt(1)
    v_mfma_f32_16x16x32_bf16 v[16:19], v[120:123], v[60:63], v[16:19]
    v_mfma_f32_16x16x32_bf16 v[20:23], v[120:123], v[76:79], v[20:23]
    v_mfma_f32_16x16x32_bf16 v[24:27], v[120:123], v[92:95], v[24:27]
    s_waitcnt lgkmcnt(0)
    v_mfma_f32_16x16x32_bf16 v[28:31], v[124:127], v[60:63], v[28:31]
    v_mfma_f32_16x16x32_bf16 v[32:35], v[124:127], v[76:79], v[32:35]
    v_mfma_f32_16x16x32_bf16 v[36:39], v[124:127], v[92:95], v[36:39]
    s_mov_b32 s79, 0x6fe000
    s_cmp_lt_u32 s3, 12
    s_cselect_b32 s64, s79, 0x7ff00000
    s_mov_b64 s[4:5], 0
    s_mov_b64 s[6:7], 0
    s_mov_b64 s[8:9], 0
    s_mov_b64 s[10:11], 0
    s_mov_b64 s[12:13], 0
    s_mov_b64 s[14:15], 0
    s_mov_b64 s[16:17], 0
    s_mov_b64 s[18:19], 0
    v_mul_f32 v48, s60, v17
    v_mul_f32 v49, s60, v19
    v_mul_f32 v50, s60, v16
    v_mul_f32 v51, s60, v18
    ds_write_b128 v41, v[48:51] offset:0
    v_mul_f32 v52, s60, v29
    v_mul_f32 v53, s60, v31
    v_mul_f32 v54, s60, v28
    v_mul_f32 v55, s60, v30
    ds_write_b128 v41, v[52:55] offset:16
    v_mul_f32 v56, s60, v21
    v_mul_f32 v57, s60, v23
    v_mul_f32 v58, s60, v20
    v_mul_f32 v59, s60, v22
    ds_write_b128 v41, v[56:59] offset:16640
    v_mul_f32 v60, s60, v33
    v_mul_f32 v61, s60, v35
    v_mul_f32 v62, s60, v32
    v_mul_f32 v63, s60, v34
    ds_write_b128 v41, v[60:63] offset:16656
    v_mul_f32 v64, s60, v25
    v_mul_f32 v65, s60, v27
    v_mul_f32 v66, s60, v24
    v_mul_f32 v67, s60, v26
    s_mov_b64 exec, s[90:91]
    ds_write_b128 v41, v[64:67] offset:33280
    s_mov_b64 exec, -1
    v_mul_f32 v68, s60, v37
    v_mul_f32 v69, s60, v39
    v_mul_f32 v70, s60, v36
    v_mul_f32 v71, s60, v38
    s_mov_b64 exec, s[90:91]
    ds_write_b128 v41, v[68:71] offset:33296
    s_mov_b64 exec, -1
    v_and_b32 v36, 15, v1
    v_lshrrev_b32 v37, 4, v1
    v_mov_b32 v38, 0
    v_mov_b32 v39, 0
    v_mov_b32 v41, s89
    v_mov_b32 v42, 0
    v_mov_b32 v83, 0
    s_cmp_ge_u32 s3, 12
    s_cbranch_scc1 K_B3
    s_movk_i32 s78, 762
    v_cmp_gt_u32 s[82:83], s78, v0
    s_mov_b32 s67, 1048576
K_AW6:
    ds_read_b32 v12, v47 offset:876
    s_waitcnt lgkmcnt(0)
    v_readfirstlane_b32 s81, v12
    s_cmp_ge_u32 s81, 4
    s_cbranch_scc1 K_AWD6
    s_sub_u32 s67, s67, 1
    s_cbranch_scc1 K_END
    s_sleep 2
    s_branch K_AW6
K_AWD6:
    s_mov_b32 s67, 1048576
K_AW7:
    ds_read_b32 v12, v47 offset:884
    s_waitcnt lgkmcnt(0)
    v_readfirstlane_b32 s81, v12
    s_cmp_ge_u32 s81, 8
    s_cbranch_scc1 K_AWD7
    s_sub_u32 s67, s67, 1
    s_cbranch_scc1 K_END
    s_sleep 2
    s_branch K_AW7
K_AWD7:
    buffer_load_dword v40, v6, s[32:35], s64 offen sc1
    s_mov_b32 s67, 65536
K_PFL:
    s_waitcnt vmcnt(0)
    v_cmp_ne_u32 vcc, s66, v40
    s_and_b64 vcc, vcc, s[82:83]
    s_cbranch_scc0 K_B3
    s_sub_u32 s67, s67, 1
    s_cbranch_scc1 K_B3
    s_mov_b64 exec, vcc
    buffer_load_dword v40, v6, s[32:35], s64 offen sc1
    s_mov_b64 exec, -1
    s_branch K_PFL
K_AUX:
    s_cmp_lg_u32 s3, 0
    s_cbranch_scc1 K_AUX1
    v_lshlrev_b32 v12, 3, v1
    s_mul_i32 s78, s2, 2560
    s_mul_i32 s79, s2, 1280
    s_waitcnt lgkmcnt(0)
    s_add_u32 s40, s10, s78
    s_addc_u32 s41, s11, 0
    s_and_b32 s41, s41, 0xffff
    s_mov_b32 s42, 0xa00
    s_mov_b32 s43, 0x20000
    buffer_load_dwordx2 v[48:49], v12, s[40:43], 0 offen offset:0
    buffer_load_dwordx2 v[50:51], v12, s[40:43], 0 offen offset:512
    buffer_load_dwordx2 v[52:53], v12, s[40:43], 0 offen offset:1024
    buffer_load_dwordx2 v[54:55], v12, s[40:43], 0 offen offset:1536
    buffer_load_dwordx2 v[56:57], v12, s[40:43], 0 offen offset:2048
    s_add_u32 s44, s8, s78
    s_addc_u32 s45, s9, 0
    s_and_b32 s45, s45, 0xffff
    s_mov_b32 s46, 0xa00
    s_mov_b32 s47, 0x20000
    buffer_load_dwordx2 v[58:59], v12, s[44:47], 0 offen offset:0
    buffer_load_dwordx2 v[60:61], v12, s[44:47], 0 offen offset:512
    buffer_load_dwordx2 v[62:63], v12, s[44:47], 0 offen offset:1024
    buffer_load_dwordx2 v[64:65], v12, s[44:47], 0 offen offset:1536
    buffer_load_dwordx2 v[66:67], v12, s[44:47], 0 offen offset:2048
    s_add_u32 s48, s6, s79
    s_addc_u32 s49, s7, 0
    s_and_b32 s49, s49, 0xffff
    s_mov_b32 s50, 0x500
    s_mov_b32 s51, 0x20000
    buffer_load_dword v68, v2, s[48:51], 0 offen offset:0
    buffer_load_dword v69, v2, s[48:51], 0 offen offset:256
    buffer_load_dword v70, v2, s[48:51], 0 offen offset:512
    buffer_load_dword v71, v2, s[48:51], 0 offen offset:768
    buffer_load_dword v72, v2, s[48:51], 0 offen offset:1024
    s_barrier
    s_setprio 3
    s_mov_b32 s32, s24
    s_and_b32 s33, s25, 0xffff
    s_mov_b32 s34, 0x10000000
    s_mov_b32 s35, 0x20000
    s_lshl_b32 s85, s3, 10
    s_add_u32 s85, s85, 35840
    s_mov_b32 s62, 0
    s_sub_u32 s28, s24, 0x4b000000
    s_subb_u32 s29, s25, 0
    s_and_b32 s29, s29, 0xffff
    s_mov_b32 s30, 0x4b4e2000
    s_mov_b32 s31, 0x20000
    s_lshl_b32 s75, s2, 3
    s_add_u32 s75, s75, 0x680000
    v_cvt_f32_u32 v3, v2
    v_lshlrev_b32 v4, 3, v1
    v_add_u32 v4, 14720, v4
    v_add_u32 v7, 56320, v5
    v_cmp_gt_u32 s[90:91], 8, v36
    s_lshl_b32 s87, s74, 8
    s_lshl_b32 s80, s3, 5
    s_add_u32 s87, s87, s80
    s_mov_b32 s63, 1
    s_mov_b32 s36, s22
    s_and_b32 s37, s23, 0xffff
    s_mov_b32 s38, 0x100
    s_mov_b32 s39, 0x20000
    s_movk_i32 s79, -40
    s_waitcnt vmcnt(14)
    buffer_load_dword v33, v47, s[36:39], 0 offen sc1
    v_mul_u32_u24 v14, 0xcccd, v48
    v_lshrrev_b32 v14, 21, v14
    v_lshlrev_b32 v84, 2, v14
    ds_add_rtn_u32 v74, v84, v46 offset:3456
    v_mad_i32_i24 v48, v14, s79, v48
    v_mul_u32_u24 v14, 0xcccd, v49
    v_lshrrev_b32 v14, 21, v14
    v_lshlrev_b32 v85, 2, v14
    ds_add_rtn_u32 v75, v85, v46 offset:3456
    v_mad_i32_i24 v49, v14, s79, v49
    s_waitcnt vmcnt(13)
    v_mul_u32_u24 v14, 0xcccd, v50
    v_lshrrev_b32 v14, 21, v14
    v_lshlrev_b32 v86, 2, v14
    ds_add_rtn_u32 v76, v86, v46 offset:3456
    v_mad_i32_i24 v50, v14, s79, v50
    v_mul_u32_u24 v14, 0xcccd, v51
    v_lshrrev_b32 v14, 21, v14
    v_lshlrev_b32 v87, 2, v14
    ds_add_rtn_u32 v77, v87, v46 offset:3456
    v_mad_i32_i24 v51, v14, s79, v51
    s_waitcnt vmcnt(12)
    v_mul_u32_u24 v14, 0xcccd, v52
    v_lshrrev_b32 v14, 21, v14
    v_lshlrev_b32 v88, 2, v14
    ds_add_rtn_u32 v78, v88, v46 offset:3456
    v_mad_i32_i24 v52, v14, s79, v52
    v_mul_u32_u24 v14, 0xcccd, v53
    v_lshrrev_b32 v14, 21, v14
    v_lshlrev_b32 v89, 2, v14
    ds_add_rtn_u32 v79, v89, v46 offset:3456
    v_mad_i32_i24 v53, v14, s79, v53
    s_waitcnt vmcnt(11)
    v_mul_u32_u24 v14, 0xcccd, v54
    v_lshrrev_b32 v14, 21, v14
    v_lshlrev_b32 v90, 2, v14
    ds_add_rtn_u32 v80, v90, v46 offset:3456
    v_mad_i32_i24 v54, v14, s79, v54
    v_mul_u32_u24 v14, 0xcccd, v55
    v_lshrrev_b32 v14, 21, v14
    v_lshlrev_b32 v91, 2, v14
    ds_add_rtn_u32 v81, v91, v46 offset:3456
    v_mad_i32_i24 v55, v14, s79, v55
    s_waitcnt vmcnt(10)
    v_mul_u32_u24 v14, 0xcccd, v56
    v_lshrrev_b32 v14, 21, v14
    v_lshlrev_b32 v92, 2, v14
    ds_add_rtn_u32 v82, v92, v46 offset:3456
    v_mad_i32_i24 v56, v14, s79, v56
    v_mul_u32_u24 v14, 0xcccd, v57
    v_lshrrev_b32 v14, 21, v14
    v_lshlrev_b32 v93, 2, v14
    ds_add_rtn_u32 v83, v93, v46 offset:3456
    v_mad_i32_i24 v57, v14, s79, v57
    ds_read_b128 v[16:19], v5 offset:3456
    s_waitcnt vmcnt(1)
    v_lshlrev_b32 v14, 16, v68
    v_lshl_or_b32 v97, v48, 2, v14
    v_and_b32 v14, 0xffff0000, v68
    v_lshl_or_b32 v99, v49, 2, v14
    v_lshlrev_b32 v14, 16, v69
    v_lshl_or_b32 v101, v50, 2, v14
    v_and_b32 v14, 0xffff0000, v69
    v_lshl_or_b32 v103, v51, 2, v14
    v_lshlrev_b32 v14, 16, v70
    v_lshl_or_b32 v105, v52, 2, v14
    v_and_b32 v14, 0xffff0000, v70
    v_lshl_or_b32 v107, v53, 2, v14
    v_lshlrev_b32 v14, 16, v71
    v_lshl_or_b32 v109, v54, 2, v14
    v_and_b32 v14, 0xffff0000, v71
    v_lshl_or_b32 v111, v55, 2, v14
    v_lshlrev_b32 v14, 16, v72
    v_lshl_or_b32 v113, v56, 2, v14
    v_and_b32 v14, 0xffff0000, v72
    v_lshl_or_b32 v115, v57, 2, v14
    s_waitcnt lgkmcnt(0)
    v_add_u32 v22, v16, v17
    v_add_u32 v23, v22, v18
    v_add_u32 v15, v23, v19
    s_nop 1
    v_add_u32_dpp v20, v15, v15 row_shr:1 row_mask:0xf bank_mask:0xf bound_ctrl:0
    s_nop 1
    v_add_u32_dpp v20, v20, v20 row_shr:2 row_mask:0xf bank_mask:0xf bound_ctrl:0
    s_nop 1
    v_add_u32_dpp v20, v20, v20 row_shr:4 row_mask:0xf bank_mask:0xf bound_ctrl:0
    s_nop 1
    v_add_u32_dpp v20, v20, v20 row_shr:8 row_mask:0xf bank_mask:0xf bound_ctrl:0
    s_nop 1
    v_add_u32_dpp v20, v20, v20 row_bcast:15 row_mask:0xa bank_mask:0xf
    s_nop 1
    v_add_u32_dpp v20, v20, v20 row_bcast:31 row_mask:0xc bank_mask:0xf
    v_sub_u32 v20, v20, v15
    v_add_u32 v21, v20, v16
    v_add_u32 v22, v20, v22
    v_add_u32 v23, v20, v23
    ds_write_b128 v5, v[20:23] offset:3456
    ds_read_b32 v48, v84 offset:3456
    ds_read_b32 v49, v85 offset:3456
    ds_read_b32 v50, v86 offset:3456
    ds_read_b32 v51, v87 offset:3456
    ds_read_b32 v52, v88 offset:3456
    ds_read_b32 v53, v89 offset:3456
    ds_read_b32 v54, v90 offset:3456
    ds_read_b32 v55, v91 offset:3456
    ds_read_b32 v56, v92 offset:3456
    ds_read_b32 v57, v93 offset:3456
    v_lshl_or_b32 v25, v16, 16, v20
    v_lshl_or_b32 v27, v17, 16, v21
    v_lshl_or_b32 v29, v18, 16, v22
    v_lshl_or_b32 v31, v19, 16, v23
    v_lshlrev_b32 v32, 1, v5
    s_mov_b32 s67, 65536
    s_waitcnt vmcnt(0)
K_TOK:
    v_readfirstlane_b32 s66, v33
    s_cmp_lg_u32 s66, 0
    s_cbranch_scc1 K_TOKOK
    s_sub_u32 s67, s67, 1
    s_cbranch_scc1 K_END
    buffer_load_dword v33, v47, s[36:39], 0 offen sc1
    s_waitcnt vmcnt(0)
    s_branch K_TOK
K_TOKOK:
    s_lshl_b32 s78, s66, 13
    s_and_b32 s78, s78, 0xffffc000
    s_lshl_b32 s81, s2, 11
    s_add_u32 s81, s81, 0x680000
    v_mov_b32 v24, s66
    v_mov_b32 v26, s66
    v_mov_b32 v28, s66
    v_mov_b32 v30, s66
    buffer_store_dwordx4 v[24:27], v32, s[32:35], s81 offen sc1
    buffer_store_dwordx4 v[28:31], v32, s[32:35], s81 offen offset:16 sc1
    s_waitcnt lgkmcnt(0)
    v_or_b32 v96, s78, v58
    v_add_lshl_u32 v48, v48, v74, 3
    ds_write_b64 v48, v[96:97] offset:24960
    v_or_b32 v98, s78, v59
    v_add_lshl_u32 v49, v49, v75, 3
    ds_write_b64 v49, v[98:99] offset:24960
    v_or_b32 v100, s78, v60
    v_add_lshl_u32 v50, v50, v76, 3
    ds_write_b64 v50, v[100:101] offset:24960
    v_or_b32 v102, s78, v61
    v_add_lshl_u32 v51, v51, v77, 3
    ds_write_b64 v51, v[102:103] offset:24960
    v_or_b32 v104, s78, v62
    v_add_lshl_u32 v52, v52, v78, 3
    ds_write_b64 v52, v[104:105] offset:24960
    v_or_b32 v106, s78, v63
    v_add_lshl_u32 v53, v53, v79, 3
    ds_write_b64 v53, v[106:107] offset:24960
    v_or_b32 v108, s78, v64
    v_add_lshl_u32 v54, v54, v80, 3
    ds_write_b64 v54, v[108:109] offset:24960
    v_or_b32 v110, s78, v65
    v_add_lshl_u32 v55, v55, v81, 3
    ds_write_b64 v55, v[110:111] offset:24960
    v_or_b32 v112, s78, v66
    v_add_lshl_u32 v56, v56, v82, 3
    ds_write_b64 v56, v[112:113] offset:24960
    v_or_b32 v114, s78, v67
    v_add_lshl_u32 v57, v57, v83, 3
    ds_write_b64 v57, v[114:115] offset:24960
    ds_read_b128 v[60:63], v5 offset:24960
    ds_read_b128 v[64:67], v5 offset:25984
    ds_read_b128 v[68:71], v5 offset:27008
    ds_read_b128 v[72:75], v5 offset:28032
    ds_read_b128 v[76:79], v5 offset:29056
    s_mul_i32 s78, s2, 5120
    s_add_u32 s78, s78, 0x500000
    s_add_u32 s79, s78, 4096
    s_waitcnt lgkmcnt(4)
    buffer_store_dwordx4 v[60:63], v5, s[32:35], s78 offen offset:0 sc1
    s_waitcnt lgkmcnt(3)
    buffer_store_dwordx4 v[64:67], v5, s[32:35], s78 offen offset:1024 sc1
    s_waitcnt lgkmcnt(2)
    buffer_store_dwordx4 v[68:71], v5, s[32:35], s78 offen offset:2048 sc1
    s_waitcnt lgkmcnt(1)
    buffer_store_dwordx4 v[72:75], v5, s[32:35], s78 offen offset:3072 sc1
    s_waitcnt lgkmcnt(0)
    buffer_store_dwordx4 v[76:79], v5, s[32:35], s79 offen offset:0 sc1
    ds_write_b32 v47, v33 offset:892
    s_setprio 0
    s_branch K_AUXP
K_AUX1:
    v_xor_b32 v51, v37, v36
    v_lshlrev_b32 v51, 4, v51
    v_lshl_add_u32 v51, v37, 8, v51
    v_xor_b32 v52, v37, v36
    v_xor_b32 v52, 4, v52
    v_lshlrev_b32 v52, 4, v52
    v_lshl_add_u32 v52, v37, 8, v52
    v_xor_b32 v53, v37, v36
    v_xor_b32 v53, 8, v53
    v_lshlrev_b32 v53, 4, v53
    v_lshl_add_u32 v53, v37, 8, v53
    v_xor_b32 v54, v37, v36
    v_xor_b32 v54, 12, v54
    v_lshlrev_b32 v54, 4, v54
    v_lshl_add_u32 v54, v37, 8, v54
    s_sub_u32 s78, s3, 1
    s_lshl_b32 s78, s78, 12
    s_lshl_b32 s80, s55, 8
    s_add_u32 s80, s80, s78
    s_add_u32 s78, s78, 35840
    s_mov_b32 m0, s78
    s_waitcnt lgkmcnt(0)
    s_cmp_ge_u32 s3, 6
    s_cbranch_scc1 K_NOX
    s_mov_b32 s40, s4
    s_and_b32 s41, s5, 0xffff
    s_mov_b32 s42, 0x271000
    s_mov_b32 s43, 0x20000
    buffer_load_dwordx4 v51, s[40:43], s80 offen offset:0 lds
    buffer_load_dwordx4 v52, s[40:43], s80 offen offset:1024 lds
    buffer_load_dwordx4 v53, s[40:43], s80 offen offset:2048 lds
    buffer_load_dwordx4 v54, s[40:43], s80 offen offset:3072 lds
K_NOX:
    s_xor_b32 s78, s3, 7
    s_or_b32 s78, s78, s2
    s_cbranch_scc1 K_NOTOK
    s_mov_b32 s36, s22
    s_and_b32 s37, s23, 0xffff
    s_mov_b32 s38, 0x100
    s_mov_b32 s39, 0x20000
    s_or_b32 s26, s26, 1
    v_mov_b32 v59, s26
    buffer_store_dword v59, v2, s[36:39], 0 offen sc1
K_NOTOK:
    s_barrier
    s_mov_b32 s32, s24
    s_and_b32 s33, s25, 0xffff
    s_mov_b32 s34, 0x10000000
    s_mov_b32 s35, 0x20000
    s_lshl_b32 s85, s3, 10
    s_add_u32 s85, s85, 35840
    s_mov_b32 s62, 0
    s_sub_u32 s28, s24, 0x4b000000
    s_subb_u32 s29, s25, 0
    s_and_b32 s29, s29, 0xffff
    s_mov_b32 s30, 0x4b4e2000
    s_mov_b32 s31, 0x20000
    s_lshl_b32 s75, s2, 3
    s_add_u32 s75, s75, 0x680000
    v_cvt_f32_u32 v3, v2
    v_lshlrev_b32 v4, 3, v1
    v_add_u32 v4, 14720, v4
    v_add_u32 v7, 56320, v5
    v_cmp_gt_u32 s[90:91], 8, v36
    s_lshl_b32 s87, s74, 8
    s_lshl_b32 s80, s3, 5
    s_add_u32 s87, s87, s80
    s_mov_b32 s63, 1
    s_cmp_lt_u32 s3, 4
    s_cbranch_scc1 K_NOCV
    v_and_b32 v63, 3, v0
    v_lshlrev_b32 v63, 2, v63
    v_mov_b32 v64, 0x2031
    v_bfe_u32 v65, v64, v63, 4
    v_bfe_u32 v64, v0, 2, 2
    v_lshl_add_u32 v64, v37, 5, v64
    v_bfe_u32 v66, v0, 6, 1
    v_lshl_add_u32 v64, v66, 2, v64
    v_bfe_u32 v66, v0, 7, 1
    v_lshl_add_u32 v64, v66, 7, v64
    v_lshl_add_u32 v65, v65, 3, v64
    v_lshl_add_u32 v64, v63, 1, v64
    v_lshlrev_b32 v65, 1, v65
    v_lshlrev_b32 v64, 1, v64
    v_and_b32 v66, 0xff, v0
    v_lshlrev_b32 v67, 1, v66
    v_lshlrev_b32 v66, 2, v66
    s_mov_b32 s44, s12
    s_and_b32 s45, s13, 0xffff
    s_mov_b32 s46, 0x20200
    s_mov_b32 s47, 0x20000
    s_mov_b32 s78, 131072
    buffer_load_ushort v20, v65, s[44:47], s78 offen
    s_mov_b32 s40, s14
    s_and_b32 s41, s15, 0xffff
    s_mov_b32 s42, 0x200
    s_mov_b32 s43, 0x20000
    buffer_load_ushort v21, v64, s[40:43], 0 offen
    s_mov_b32 s40, s18
    s_and_b32 s41, s19, 0xffff
    s_mov_b32 s42, 0x100
    s_mov_b32 s43, 0x20000
    buffer_load_ushort v22, v67, s[40:43], 0 offen
    s_cmp_ge_u32 s3, 6
    s_cbranch_scc1 K_CV1
    s_waitcnt vmcnt(3)
    s_mov_b64 exec, 1
    ds_add_u32 v47, v46 offset:864
    s_mov_b64 exec, -1
K_CV1:
    s_cmp_lg_u32 s3, 7
    s_cbranch_scc1 K_CV1B
    s_cmp_ge_u32 s2, 64
    s_cbranch_scc1 K_CV1B
    s_bfe_u32 s78, s2, 0x10002
    s_lshl_b32 s78, s78, 15
    s_and_b32 s79, s2, 1
    s_lshl_b32 s79, s79, 14
    s_add_u32 s78, s78, s79
    s_bfe_u32 s79, s2, 0x10001
    s_lshl_b32 s79, s79, 10
    s_add_u32 s78, s78, s79
    s_lshr_b32 s79, s2, 3
    s_lshl_b32 s79, s79, 5
    s_add_u32 s78, s78, s79
    s_add_u32 s79, s78, 4096
    v_lshrrev_b32 v24, 1, v37
    v_lshlrev_b32 v24, 13, v24
    v_and_b32 v25, 1, v37
    v_lshl_add_u32 v24, v25, 9, v24
    v_lshl_add_u32 v24, v36, 1, v24
    s_mov_b32 s40, s16
    s_and_b32 s41, s17, 0xffff
    s_mov_b32 s42, 0x10000
    s_mov_b32 s43, 0x20000
    buffer_load_ushort v72, v24, s[40:43], s78 offen offset:2048
    buffer_load_ushort v73, v24, s[40:43], s79 offen offset:2048
    buffer_load_ushort v74, v24, s[40:43], s78 offen offset:0
    buffer_load_ushort v75, v24, s[40:43], s79 offen offset:0
    buffer_load_ushort v76, v24, s[40:43], s78 offen offset:2304
    buffer_load_ushort v77, v24, s[40:43], s79 offen offset:2304
    buffer_load_ushort v78, v24, s[40:43], s78 offen offset:256
    buffer_load_ushort v79, v24, s[40:43], s79 offen offset:256
    s_lshl_b32 s78, s2, 10
    s_add_u32 s78, s78, 0x710000
    s_waitcnt vmcnt(0)
    v_lshl_or_b32 v80, v73, 16, v72
    v_lshl_or_b32 v81, v75, 16, v74
    v_lshl_or_b32 v82, v77, 16, v76
    v_lshl_or_b32 v83, v79, 16, v78
    buffer_store_dwordx4 v[80:83], v5, s[32:35], s78 offen sc1
K_CV1B:
    s_waitcnt vmcnt(0)
    v_lshlrev_b32 v20, 16, v20
    v_lshlrev_b32 v21, 16, v21
    v_lshlrev_b32 v22, 16, v22
    v_mul_f32 v20, s60, v20
    ds_write_b32 v66, v21 offset:1920
    ds_write_b32 v66, v20 offset:896
    s_cmp_ge_u32 s3, 6
    s_cbranch_scc1 K_CV2
    ds_write_b32 v66, v22 offset:2944
K_CV2:
    s_waitcnt lgkmcnt(0)
    s_mov_b64 exec, 1
    ds_add_u32 v47, v46 offset:872
    s_mov_b64 exec, -1
    s_cmp_lg_u32 s3, 7
    s_cbranch_scc1 K_AUXT
    s_mov_b64 exec, 1
    ds_add_u32 v47, v46 offset:868
    s_mov_b64 exec, -1
    s_branch K_AUXT
K_NOCV:
    s_waitcnt vmcnt(0)
    s_mov_b64 exec, 1
    ds_add_u32 v47, v46 offset:864
    s_mov_b64 exec, -1
K_AUXT:
K_AUXP:
    v_lshrrev_b32 v31, 1, v0
    v_lshlrev_b32 v31, 11, v31
    s_movk_i32 s81, 500
    v_cmp_gt_u32 s[52:53], s81, v0
    v_cvt_f32_u32 v30, v1
    v_rcp_f32 v30, v30
    v_mov_b32 v41, s89
    v_mul_f32 v30, 0x47800000, v30
    v_cvt_u32_f32 v30, v30
    v_add_u32 v30, 1, v30
    s_mov_b32 s67, 1048576
K_AW8:
    ds_read_b32 v33, v47 offset:892
    s_waitcnt lgkmcnt(0)
    v_readfirstlane_b32 s66, v33
    s_cmp_lg_u32 s66, 0
    s_cbranch_scc1 K_AWD8
    s_sub_u32 s67, s67, 1
    s_cbranch_scc1 K_END
    s_sleep 4
    s_branch K_AW8
K_AWD8:
    s_bfe_u32 s54, s66, 0x120001
K_REC0:
    s_mov_b32 s67, 65536
    s_mov_b64 vcc, s[52:53]
K_OFS:
    s_mov_b64 exec, vcc
    buffer_load_dwordx2 v[34:35], v31, s[32:35], s75 offen sc1
    s_mov_b64 exec, -1
K_OFS1:
    s_waitcnt vmcnt(0)
    v_cmp_ne_u32 vcc, s66, v34
    s_and_b64 vcc, vcc, s[52:53]
    s_cbranch_scc0 K_OFSOK
    s_sub_u32 s67, s67, 1
    s_cbranch_scc1 K_END
    s_sleep 2
    s_branch K_OFS
K_OFSOK:
    v_lshrrev_b32 v34, 16, v35
    v_and_b32 v35, 0xffff, v35
    v_cndmask_b32 v34, 0, v34, s[52:53]
    v_lshrrev_b32 v32, 1, v0
    s_movk_i32 s78, 640
    v_mad_u32_u24 v35, v32, s78, v35
    v_and_b32 v32, 1, v0
    v_lshlrev_b32 v32, 1, v32
    v_add_lshl_u32 v39, v35, v32, 3
    v_sub_i32 v38, v34, v32
    v_mov_b32 v42, 0
    v_mov_b32 v83, 0
K_RECS:
    s_mov_b32 s78, 0x500000
    v_cmp_lt_i32 s[4:5], 0, v38
    v_cmp_lt_i32 s[6:7], 1, v38
    v_cmp_lt_i32 s[8:9], 4, v38
    v_cmp_lt_i32 s[10:11], 5, v38
    v_cmp_lt_i32 s[12:13], 8, v38
    v_cmp_lt_i32 s[14:15], 9, v38
    v_cmp_lt_i32 s[16:17], 12, v38
    v_cmp_lt_i32 s[18:19], 13, v38
    v_cmp_lt_i32 vcc, 16, v38
    v_mov_b32 v88, 4
    v_mov_b32 v89, 0
    v_mov_b32 v90, 1
    s_cbranch_vccz K_RM
    ds_write_b32 v89, v90 offset:256
K_RM:
    s_mov_b32 s67, 65536
K_RLD:
    s_mov_b64 exec, s[4:5]
    s_cbranch_execz K_RL
    buffer_load_dwordx4 v[96:99], v39, s[32:35], s78 offen offset:0 sc1
    s_mov_b64 exec, s[8:9]
    s_cbranch_execz K_RL
    buffer_load_dwordx4 v[100:103], v39, s[32:35], s78 offen offset:32 sc1
    s_mov_b64 exec, s[12:13]
    s_cbranch_execz K_RL
    buffer_load_dwordx4 v[104:107], v39, s[32:35], s78 offen offset:64 sc1
    s_mov_b64 exec, s[16:17]
    s_cbranch_execz K_RL
    buffer_load_dwordx4 v[108:111], v39, s[32:35], s78 offen offset:96 sc1
K_RL:
    s_mov_b64 exec, -1
K_NOU:
    s_mov_b64 s[82:83], 0
    s_waitcnt vmcnt(0)
    s_mov_b64 exec, s[4:5]
    s_cbranch_execz K_RV
    v_lshrrev_b32 v91, 14, v96
    v_cmp_ne_u32 vcc, s54, v91
    s_or_b64 s[82:83], s[82:83], vcc
    s_mov_b64 exec, s[6:7]
    s_cbranch_execz K_RV
    v_lshrrev_b32 v91, 14, v98
    v_cmp_ne_u32 vcc, s54, v91
    s_or_b64 s[82:83], s[82:83], vcc
    s_mov_b64 exec, s[8:9]
    s_cbranch_execz K_RV
    v_lshrrev_b32 v91, 14, v100
    v_cmp_ne_u32 vcc, s54, v91
    s_or_b64 s[82:83], s[82:83], vcc
    s_mov_b64 exec, s[10:11]
    s_cbranch_execz K_RV
    v_lshrrev_b32 v91, 14, v102
    v_cmp_ne_u32 vcc, s54, v91
    s_or_b64 s[82:83], s[82:83], vcc
    s_mov_b64 exec, s[12:13]
    s_cbranch_execz K_RV
    v_lshrrev_b32 v91, 14, v104
    v_cmp_ne_u32 vcc, s54, v91
    s_or_b64 s[82:83], s[82:83], vcc
    s_mov_b64 exec, s[14:15]
    s_cbranch_execz K_RV
    v_lshrrev_b32 v91, 14, v106
    v_cmp_ne_u32 vcc, s54, v91
    s_or_b64 s[82:83], s[82:83], vcc
    s_mov_b64 exec, s[16:17]
    s_cbranch_execz K_RV
    v_lshrrev_b32 v91, 14, v108
    v_cmp_ne_u32 vcc, s54, v91
    s_or_b64 s[82:83], s[82:83], vcc
    s_mov_b64 exec, s[18:19]
    s_cbranch_execz K_RV
    v_lshrrev_b32 v91, 14, v110
    v_cmp_ne_u32 vcc, s54, v91
    s_or_b64 s[82:83], s[82:83], vcc
K_RV:
    s_mov_b64 exec, -1
    s_cmp_eq_u64 s[82:83], 0
    s_cbranch_scc1 K_RVOK
    s_sub_u32 s67, s67, 1
    s_cbranch_scc1 K_END
    s_sleep 2
    s_branch K_RLD
K_RVOK:
    s_mov_b32 s79, 0x4b000000
    s_mov_b64 exec, s[4:5]
    s_cbranch_execz K_R1
    v_and_b32 v64, 0xfc, v97
    ds_add_rtn_u32 v72, v64, v88
    v_and_b32 v96, 0x3fff, v96
    v_lshl_or_b32 v96, v96, 9, s79
    s_mov_b64 exec, s[6:7]
    s_cbranch_execz K_R1
    v_and_b32 v65, 0xfc, v99
    ds_add_rtn_u32 v73, v65, v88
    v_and_b32 v98, 0x3fff, v98
    v_lshl_or_b32 v98, v98, 9, s79
    s_mov_b64 exec, s[8:9]
    s_cbranch_execz K_R1
    v_and_b32 v66, 0xfc, v101
    ds_add_rtn_u32 v74, v66, v88
    v_and_b32 v100, 0x3fff, v100
    v_lshl_or_b32 v100, v100, 9, s79
    s_mov_b64 exec, s[10:11]
    s_cbranch_execz K_R1
    v_and_b32 v67, 0xfc, v103
    ds_add_rtn_u32 v75, v67, v88
    v_and_b32 v102, 0x3fff, v102
    v_lshl_or_b32 v102, v102, 9, s79
    s_mov_b64 exec, s[12:13]
    s_cbranch_execz K_R1
    v_and_b32 v68, 0xfc, v105
    ds_add_rtn_u32 v76, v68, v88
    v_and_b32 v104, 0x3fff, v104
    v_lshl_or_b32 v104, v104, 9, s79
    s_mov_b64 exec, s[14:15]
    s_cbranch_execz K_R1
    v_and_b32 v69, 0xfc, v107
    ds_add_rtn_u32 v77, v69, v88
    v_and_b32 v106, 0x3fff, v106
    v_lshl_or_b32 v106, v106, 9, s79
    s_mov_b64 exec, s[16:17]
    s_cbranch_execz K_R1
    v_and_b32 v70, 0xfc, v109
    ds_add_rtn_u32 v78, v70, v88
    v_and_b32 v108, 0x3fff, v108
    v_lshl_or_b32 v108, v108, 9, s79
    s_mov_b64 exec, s[18:19]
    s_cbranch_execz K_R1
    v_and_b32 v71, 0xfc, v111
    ds_add_rtn_u32 v79, v71, v88
    v_and_b32 v110, 0x3fff, v110
    v_lshl_or_b32 v110, v110, 9, s79
K_R1:
    s_mov_b64 exec, 1
    s_waitcnt lgkmcnt(0)
    ds_add_u32 v89, v90 offset:880
    s_mov_b64 exec, -1
    v_mov_b32 v47, 0
    s_mov_b32 s67, 1048576
K_AW9:
    ds_read_b32 v91, v47 offset:880
    s_waitcnt lgkmcnt(0)
    v_readfirstlane_b32 s78, v91
    s_cmp_ge_u32 s78, 8
    s_cbranch_scc1 K_AWD9
    s_sub_u32 s67, s67, 1
    s_cbranch_scc1 K_END
    s_sleep 1
    s_branch K_AW9
K_AWD9:
    ds_read_b32 v44, v2
    ds_read_b32 v91, v89 offset:256
    s_waitcnt lgkmcnt(1)
    v_add_u32_dpp v47, v44, v44 row_shr:1 row_mask:0xf bank_mask:0xf bound_ctrl:0
    v_add_u32 v42, v42, v44
    s_nop 0
    v_add_u32_dpp v47, v47, v47 row_shr:2 row_mask:0xf bank_mask:0xf bound_ctrl:0
    s_nop 1
    v_add_u32_dpp v47, v47, v47 row_shr:4 row_mask:0xf bank_mask:0xf bound_ctrl:0
    s_nop 1
    v_add_u32_dpp v47, v47, v47 row_shr:8 row_mask:0xf bank_mask:0xf bound_ctrl:0
    s_nop 1
    v_add_u32_dpp v47, v47, v47 row_bcast:15 row_mask:0xa bank_mask:0xf
    s_nop 1
    v_add_u32_dpp v47, v47, v47 row_bcast:31 row_mask:0xc bank_mask:0xf
    v_sub_u32 v43, v47, v44
    s_waitcnt lgkmcnt(0)
    v_readlane_b32 s71, v47, 63
    s_cmp_eq_u64 s[4:5], 0
    s_cbranch_scc1 K_R2a
    ds_bpermute_b32 v80, v64, v43
    s_cmp_eq_u64 s[6:7], 0
    s_cbranch_scc1 K_R2a
    ds_bpermute_b32 v81, v65, v43
    s_cmp_eq_u64 s[8:9], 0
    s_cbranch_scc1 K_R2a
    ds_bpermute_b32 v82, v66, v43
    s_cmp_eq_u64 s[10:11], 0
    s_cbranch_scc1 K_R2a
    ds_bpermute_b32 v83, v67, v43
    s_cmp_eq_u64 s[12:13], 0
    s_cbranch_scc1 K_R2a
    ds_bpermute_b32 v84, v68, v43
    s_cmp_eq_u64 s[14:15], 0
    s_cbranch_scc1 K_R2a
    ds_bpermute_b32 v85, v69, v43
    s_cmp_eq_u64 s[16:17], 0
    s_cbranch_scc1 K_R2a
    ds_bpermute_b32 v86, v70, v43
    s_cmp_eq_u64 s[18:19], 0
    s_cbranch_scc1 K_R2a
    ds_bpermute_b32 v87, v71, v43
K_R2a:
    v_readfirstlane_b32 s72, v91
    s_add_u32 s79, s71, 60
    s_lshr_b32 s86, s79, 6
    s_lshl_b32 s79, s86, 2
    s_add_u32 s80, s79, 4
    v_cmp_lt_u32 vcc, s80, v44
    s_and_b32 s81, s86, 63
    v_readlane_b32 s78, v30, s81
    s_andn2_b32 s65, s63, s62
    s_andn2_b32 s65, s65, s72
    s_cmp_gt_u32 s71, 4032
    s_cselect_b32 s65, 0, s65
    s_sub_u32 s79, 640, s79
    s_cmp_lg_u64 vcc, 0
    s_cselect_b32 s65, 0, s65
    v_mov_b32 v92, s65
    ds_write_b32 v89, v92 offset:268
    s_cmp_eq_u32 s65, 0
    s_waitcnt lgkmcnt(0)
    s_cbranch_scc1 K_WL
    s_mov_b64 exec, s[4:5]
    s_cbranch_execz K_WB
    v_add_u32 v80, v80, v72
    v_mul_u32_u24 v72, s78, v80
    v_lshrrev_b32 v72, 18, v72
    v_mad_u32_u24 v80, v72, s79, v80
    ds_write_b32 v80, v96 offset:4480
    ds_write_b32 v80, v97 offset:4800
    s_mov_b64 exec, s[6:7]
    s_cbranch_execz K_WB
    v_add_u32 v81, v81, v73
    v_mul_u32_u24 v73, s78, v81
    v_lshrrev_b32 v73, 18, v73
    v_mad_u32_u24 v81, v73, s79, v81
    ds_write_b32 v81, v98 offset:4480
    ds_write_b32 v81, v99 offset:4800
    s_mov_b64 exec, s[8:9]
    s_cbranch_execz K_WB
    v_add_u32 v82, v82, v74
    v_mul_u32_u24 v74, s78, v82
    v_lshrrev_b32 v74, 18, v74
    v_mad_u32_u24 v82, v74, s79, v82
    ds_write_b32 v82, v100 offset:4480
    ds_write_b32 v82, v101 offset:4800
    s_mov_b64 exec, s[10:11]
    s_cbranch_execz K_WB
    v_add_u32 v83, v83, v75
    v_mul_u32_u24 v75, s78, v83
    v_lshrrev_b32 v75, 18, v75
    v_mad_u32_u24 v83, v75, s79, v83
    ds_write_b32 v83, v102 offset:4480
    ds_write_b32 v83, v103 offset:4800
    s_mov_b64 exec, s[12:13]
    s_cbranch_execz K_WB
    v_add_u32 v84, v84, v76
    v_mul_u32_u24 v76, s78, v84
    v_lshrrev_b32 v76, 18, v76
    v_mad_u32_u24 v84, v76, s79, v84
    ds_write_b32 v84, v104 offset:4480
    ds_write_b32 v84, v105 offset:4800
    s_mov_b64 exec, s[14:15]
    s_cbranch_execz K_WB
    v_add_u32 v85, v85, v77
    v_mul_u32_u24 v77, s78, v85
    v_lshrrev_b32 v77, 18, v77
    v_mad_u32_u24 v85, v77, s79, v85
    ds_write_b32 v85, v106 offset:4480
    ds_write_b32 v85, v107 offset:4800
    s_mov_b64 exec, s[16:17]
    s_cbranch_execz K_WB
    v_add_u32 v86, v86, v78
    v_mul_u32_u24 v78, s78, v86
    v_lshrrev_b32 v78, 18, v78
    v_mad_u32_u24 v86, v78, s79, v86
    ds_write_b32 v86, v108 offset:4480
    ds_write_b32 v86, v109 offset:4800
    s_mov_b64 exec, s[18:19]
    s_cbranch_execz K_WB
    v_add_u32 v87, v87, v79
    v_mul_u32_u24 v79, s78, v87
    v_lshrrev_b32 v79, 18, v79
    v_mad_u32_u24 v87, v79, s79, v87
    ds_write_b32 v87, v110 offset:4480
    ds_write_b32 v87, v111 offset:4800
K_WB:
    s_mov_b64 exec, 1
    ds_add_u32 v89, v90 offset:884
    s_mov_b64 exec, -1
K_B3:
    s_mov_b32 s89, 1
    v_mov_b32 v89, 0
    s_waitcnt vmcnt(0) lgkmcnt(0)
    s_barrier
    ds_read_b32 v92, v89 offset:268
    ds_read_b128 v[16:19], v41 offset:0
    ds_read_b128 v[20:23], v41 offset:16
    ds_read_b128 v[8:11], v5 offset:896
    s_waitcnt lgkmcnt(2)
    v_readfirstlane_b32 s78, v92
    s_cmp_eq_u32 s78, 0
    s_cbranch_scc1 K_R3
    v_add_u32 v16, v16, v2
    buffer_load_dword v64, v16, s[28:31], 0 offen sc1
    buffer_load_dword v65, v16, s[28:31], 0 offen offset:256 sc1
    v_add_u32 v17, v17, v2
    buffer_load_dword v66, v17, s[28:31], 0 offen sc1
    buffer_load_dword v67, v17, s[28:31], 0 offen offset:256 sc1
    v_add_u32 v18, v18, v2
    buffer_load_dword v68, v18, s[28:31], 0 offen sc1
    buffer_load_dword v69, v18, s[28:31], 0 offen offset:256 sc1
    v_add_u32 v19, v19, v2
    buffer_load_dword v70, v19, s[28:31], 0 offen sc1
    buffer_load_dword v71, v19, s[28:31], 0 offen offset:256 sc1
K_R3:
    s_cmp_lt_u32 s3, 8
    s_cbranch_scc1 K_R4
    ds_read_b32 v44, v2
    ds_read_b32 v91, v89 offset:256
    s_waitcnt lgkmcnt(1)
    v_add_u32_dpp v47, v44, v44 row_shr:1 row_mask:0xf bank_mask:0xf bound_ctrl:0
    v_add_u32 v42, v42, v44
    s_nop 0
    v_add_u32_dpp v47, v47, v47 row_shr:2 row_mask:0xf bank_mask:0xf bound_ctrl:0
    s_nop 1
    v_add_u32_dpp v47, v47, v47 row_shr:4 row_mask:0xf bank_mask:0xf bound_ctrl:0
    s_nop 1
    v_add_u32_dpp v47, v47, v47 row_shr:8 row_mask:0xf bank_mask:0xf bound_ctrl:0
    s_nop 1
    v_add_u32_dpp v47, v47, v47 row_bcast:15 row_mask:0xa bank_mask:0xf
    s_nop 1
    v_add_u32_dpp v47, v47, v47 row_bcast:31 row_mask:0xc bank_mask:0xf
    v_sub_u32 v43, v47, v44
    s_waitcnt lgkmcnt(0)
    v_readlane_b32 s71, v47, 63
    v_readfirstlane_b32 s72, v91
    s_add_u32 s79, s71, 60
    s_lshr_b32 s86, s79, 6
    s_lshl_b32 s79, s86, 2
    s_add_u32 s80, s79, 4
    v_cmp_lt_u32 vcc, s80, v44
    s_and_b32 s81, s86, 63
    s_andn2_b32 s65, s63, s62
    s_andn2_b32 s65, s65, s72
    s_cmp_gt_u32 s71, 4032
    s_cselect_b32 s65, 0, s65
    s_sub_u32 s79, 640, s79
    s_cmp_lg_u64 vcc, 0
    s_cselect_b32 s65, 0, s65
K_R4:
    s_cmp_eq_u32 s65, 0
    s_cbranch_scc1 K_SLOW
    v_add_u32 v15, v41, v2
    ds_read_b32 v12, v15 offset:320
    ds_read_b128 v[48:51], v41 offset:320
    ds_read_b128 v[52:55], v41 offset:336
    ds_read_b128 v[56:59], v41 offset:32
    s_mul_i32 s78, s86, s3
    s_add_u32 s81, s78, s86
    s_lshl_b32 s78, s78, 2
    s_lshl_b32 s81, s81, 2
    s_min_u32 s78, s78, s71
    s_min_u32 s81, s81, s71
    s_sub_u32 s73, s81, s78
    s_lshr_b32 s73, s73, 2
    v_cmp_gt_u32 vcc, s78, v43
    v_cmp_lt_u32 s[82:83], s78, v47
    s_and_b64 vcc, vcc, s[82:83]
    s_cselect_b32 s72, 1, 0
    v_cmp_gt_u32 vcc, s81, v43
    v_cmp_lt_u32 s[82:83], s81, v47
    s_and_b64 vcc, vcc, s[82:83]
    s_cselect_b32 s84, 1, 0
    v_cmp_le_u32 vcc, s73, v1
    s_movk_i32 s80, 260
    s_movk_i32 s81, 132
    s_mov_b32 s70, s73
    s_waitcnt lgkmcnt(0)
    v_and_b32 v28, 0xfc, v48
    v_and_b32 v13, 0xfc, v12
    v_mad_u32_u24 v29, v28, s80, v7
    s_setprio 3
    v_mov_b32_dpp v14, v13 wave_shr:1 row_mask:0xf bank_mask:0xf
    v_cmp_ne_u32 s[68:69], v13, v14
    ds_read_b128 v[12:15], v29
    s_or_b64 s[68:69], s[68:69], vcc
    v_add_u32 v56, v56, v2
    v_add_u32 v57, v57, v2
    v_add_u32 v58, v58, v2
    v_add_u32 v59, v59, v2
    s_cmp_ge_u32 s3, 8
    s_cbranch_scc1 K_NOTP
    v_lshlrev_b32 v25, 2, v36
    v_lshlrev_b32 v26, 4, v37
    v_add_u32 v35, 0, v25
    ds_bpermute_b32 v32, v35, v42
    v_add_u32 v35, 64, v25
    ds_bpermute_b32 v33, v35, v42
    v_add_u32 v35, 128, v25
    ds_bpermute_b32 v34, v35, v42
    s_lshl_b32 s78, s3, 6
    v_add_u32 v27, s78, v26
    ds_read_b128 v[92:95], v27 offset:2944
    s_movk_i32 s79, 528
    v_mad_u32_u24 v80, v36, s79, v26
    v_lshlrev_b32 v83, 8, v36
    v_lshl_add_u32 v83, v37, 3, v83
    v_add_u32 v26, 352, v26
    v_add_u32 v82, 31616, v80
    v_add_u32 v81, 23168, v80
    v_add_u32 v80, 14720, v80
    s_waitcnt lgkmcnt(0)
    v_cmp_eq_u32 vcc, 0, v32
    v_cvt_f32_u32 v32, v32
    v_mul_f32 v32, 0x3e800000, v32
    v_cndmask_b32 v80, v80, v26, vcc
    v_pk_mul_f32 v[84:85], v[92:93], v[32:33] op_sel_hi:[1,0]
    v_pk_mul_f32 v[86:87], v[94:95], v[32:33] op_sel_hi:[1,0]
    v_cmp_eq_u32 vcc, 0, v33
    v_cvt_f32_u32 v33, v33
    v_mul_f32 v33, 0x3e800000, v33
    v_cndmask_b32 v81, v81, v26, vcc
    v_pk_mul_f32 v[88:89], v[92:93], v[32:33] op_sel:[0,1]
    v_pk_mul_f32 v[90:91], v[94:95], v[32:33] op_sel:[0,1]
    v_cmp_eq_u32 vcc, 0, v34
    v_cvt_f32_u32 v34, v34
    v_mul_f32 v34, 0x3e800000, v34
    v_cndmask_b32 v82, v82, v26, vcc
    v_pk_mul_f32 v[92:93], v[92:93], v[34:35] op_sel_hi:[1,0]
    v_pk_mul_f32 v[94:95], v[94:95], v[34:35] op_sel_hi:[1,0]
K_NOTP:
    v_add_u32 v20, v20, v2
    buffer_load_dword v72, v20, s[28:31], 0 offen sc1
    buffer_load_dword v73, v20, s[28:31], 0 offen offset:256 sc1
    v_add_u32 v21, v21, v2
    buffer_load_dword v74, v21, s[28:31], 0 offen sc1
    buffer_load_dword v75, v21, s[28:31], 0 offen offset:256 sc1
    v_add_u32 v22, v22, v2
    buffer_load_dword v76, v22, s[28:31], 0 offen sc1
    buffer_load_dword v77, v22, s[28:31], 0 offen offset:256 sc1
    v_add_u32 v23, v23, v2
    buffer_load_dword v78, v23, s[28:31], 0 offen sc1
    buffer_load_dword v79, v23, s[28:31], 0 offen offset:256 sc1
    v_mov_b32 v36, v28
    v_mov_b32 v38, 0
    v_mov_b32 v39, 0
    s_cmp_eq_u32 s73, 0
    s_cbranch_scc1 K_WDONE
    s_branch K_HC0
K_LOOP:
K_G0:
    s_and_b32 s78, s68, 0xf
    s_cbranch_scc1 K_S0
    v_pk_fma_f32 v[24:25], v[8:9], v[48:49], v[12:13] op_sel_hi:[1,0,1]
    v_pk_fma_f32 v[26:27], v[10:11], v[48:49], v[14:15] op_sel_hi:[1,0,1]
    s_waitcnt vmcnt(14)
    v_lshlrev_b64 v[36:37], 16, v[64:65]
    v_pk_fma_f32 v[24:25], v[64:65], s[60:61], v[24:25]
    v_pk_fma_f32 v[26:27], v[36:37], s[60:61], v[26:27]
    ds_read_b128 v[60:63], v41 offset:48
    buffer_load_dword v64, v56, s[28:31], 0 offen sc1
    buffer_load_dword v65, v56, s[28:31], 0 offen offset:256 sc1
    v_exp_f32 v32, v24
    v_pk_fma_f32 v[28:29], v[8:9], v[48:49], v[12:13] op_sel:[0,1,0]
    v_exp_f32 v33, v25
    v_pk_fma_f32 v[30:31], v[10:11], v[48:49], v[14:15] op_sel:[0,1,0]
    v_exp_f32 v34, v26
    s_waitcnt vmcnt(14)
    v_lshlrev_b64 v[36:37], 16, v[66:67]
    v_exp_f32 v35, v27
    v_pk_fma_f32 v[16:17], v[16:17], v[32:33], v[16:17]
    v_pk_fma_f32 v[28:29], v[66:67], s[60:61], v[28:29]
    v_pk_fma_f32 v[18:19], v[18:19], v[34:35], v[18:19]
    v_pk_fma_f32 v[16:17], v[24:25], v[20:21], v[16:17]
    v_pk_fma_f32 v[30:31], v[36:37], s[60:61], v[30:31]
    v_pk_fma_f32 v[18:19], v[26:27], v[22:23], v[18:19]
    buffer_load_dword v66, v57, s[28:31], 0 offen sc1
    buffer_load_dword v67, v57, s[28:31], 0 offen offset:256 sc1
    v_pk_fma_f32 v[20:21], v[20:21], v[32:33], v[20:21]
    v_pk_fma_f32 v[22:23], v[22:23], v[34:35], v[22:23]
    v_exp_f32 v32, v28
    v_pk_fma_f32 v[24:25], v[8:9], v[50:51], v[12:13] op_sel_hi:[1,0,1]
    v_exp_f32 v33, v29
    v_pk_fma_f32 v[26:27], v[10:11], v[50:51], v[14:15] op_sel_hi:[1,0,1]
    v_exp_f32 v34, v30
    s_waitcnt vmcnt(14)
    v_lshlrev_b64 v[36:37], 16, v[68:69]
    v_exp_f32 v35, v31
    v_pk_fma_f32 v[16:17], v[16:17], v[32:33], v[16:17]
    v_pk_fma_f32 v[24:25], v[68:69], s[60:61], v[24:25]
    v_pk_fma_f32 v[18:19], v[18:19], v[34:35], v[18:19]
    v_pk_fma_f32 v[16:17], v[28:29], v[20:21], v[16:17]
    v_pk_fma_f32 v[26:27], v[36:37], s[60:61], v[26:27]
    v_pk_fma_f32 v[18:19], v[30:31], v[22:23], v[18:19]
    buffer_load_dword v68, v58, s[28:31], 0 offen sc1
    buffer_load_dword v69, v58, s[28:31], 0 offen offset:256 sc1
    v_pk_fma_f32 v[20:21], v[20:21], v[32:33], v[20:21]
    v_pk_fma_f32 v[22:23], v[22:23], v[34:35], v[22:23]
    v_exp_f32 v32, v24
    v_pk_fma_f32 v[28:29], v[8:9], v[50:51], v[12:13] op_sel:[0,1,0]
    v_exp_f32 v33, v25
    v_pk_fma_f32 v[30:31], v[10:11], v[50:51], v[14:15] op_sel:[0,1,0]
    v_exp_f32 v34, v26
    s_waitcnt vmcnt(14)
    v_lshlrev_b64 v[36:37], 16, v[70:71]
    v_exp_f32 v35, v27
    v_pk_fma_f32 v[16:17], v[16:17], v[32:33], v[16:17]
    v_pk_fma_f32 v[28:29], v[70:71], s[60:61], v[28:29]
    v_pk_fma_f32 v[18:19], v[18:19], v[34:35], v[18:19]
    v_pk_fma_f32 v[16:17], v[24:25], v[20:21], v[16:17]
    v_pk_fma_f32 v[30:31], v[36:37], s[60:61], v[30:31]
    v_pk_fma_f32 v[18:19], v[26:27], v[22:23], v[18:19]
    buffer_load_dword v70, v59, s[28:31], 0 offen sc1
    buffer_load_dword v71, v59, s[28:31], 0 offen offset:256 sc1
    s_waitcnt lgkmcnt(0)
    v_pk_add_f32 v[60:61], v[60:61], v[2:3] op_sel:[0,1]
    v_pk_add_f32 v[62:63], v[62:63], v[2:3] op_sel:[0,1]
    ds_read_b128 v[48:51], v41 offset:352
    v_pk_fma_f32 v[20:21], v[20:21], v[32:33], v[20:21]
    v_pk_fma_f32 v[22:23], v[22:23], v[34:35], v[22:23]
    v_exp_f32 v32, v28
    v_exp_f32 v33, v29
    v_exp_f32 v34, v30
    v_exp_f32 v35, v31
    v_pk_fma_f32 v[16:17], v[16:17], v[32:33], v[16:17]
    v_pk_fma_f32 v[18:19], v[18:19], v[34:35], v[18:19]
    v_pk_fma_f32 v[16:17], v[28:29], v[20:21], v[16:17]
    v_pk_fma_f32 v[18:19], v[30:31], v[22:23], v[18:19]
    v_pk_fma_f32 v[20:21], v[20:21], v[32:33], v[20:21]
    v_pk_fma_f32 v[22:23], v[22:23], v[34:35], v[22:23]
K_G1:
    s_and_b32 s78, s68, 0xf0
    s_cbranch_scc1 K_S4
    v_pk_fma_f32 v[24:25], v[8:9], v[52:53], v[12:13] op_sel_hi:[1,0,1]
    v_pk_fma_f32 v[26:27], v[10:11], v[52:53], v[14:15] op_sel_hi:[1,0,1]
    s_waitcnt vmcnt(14)
    v_lshlrev_b64 v[36:37], 16, v[72:73]
    v_pk_fma_f32 v[24:25], v[72:73], s[60:61], v[24:25]
    v_pk_fma_f32 v[26:27], v[36:37], s[60:61], v[26:27]
    ds_read_b128 v[56:59], v41 offset:64
    buffer_load_dword v72, v60, s[28:31], 0 offen sc1
    buffer_load_dword v73, v60, s[28:31], 0 offen offset:256 sc1
    v_exp_f32 v32, v24
    v_pk_fma_f32 v[28:29], v[8:9], v[52:53], v[12:13] op_sel:[0,1,0]
    v_exp_f32 v33, v25
    v_pk_fma_f32 v[30:31], v[10:11], v[52:53], v[14:15] op_sel:[0,1,0]
    v_exp_f32 v34, v26
    s_waitcnt vmcnt(14)
    v_lshlrev_b64 v[36:37], 16, v[74:75]
    v_exp_f32 v35, v27
    v_pk_fma_f32 v[16:17], v[16:17], v[32:33], v[16:17]
    v_pk_fma_f32 v[28:29], v[74:75], s[60:61], v[28:29]
    v_pk_fma_f32 v[18:19], v[18:19], v[34:35], v[18:19]
    v_pk_fma_f32 v[16:17], v[24:25], v[20:21], v[16:17]
    v_pk_fma_f32 v[30:31], v[36:37], s[60:61], v[30:31]
    v_pk_fma_f32 v[18:19], v[26:27], v[22:23], v[18:19]
    buffer_load_dword v74, v61, s[28:31], 0 offen sc1
    buffer_load_dword v75, v61, s[28:31], 0 offen offset:256 sc1
    v_pk_fma_f32 v[20:21], v[20:21], v[32:33], v[20:21]
    v_pk_fma_f32 v[22:23], v[22:23], v[34:35], v[22:23]
    v_exp_f32 v32, v28
    v_pk_fma_f32 v[24:25], v[8:9], v[54:55], v[12:13] op_sel_hi:[1,0,1]
    v_exp_f32 v33, v29
    v_pk_fma_f32 v[26:27], v[10:11], v[54:55], v[14:15] op_sel_hi:[1,0,1]
    v_exp_f32 v34, v30
    s_waitcnt vmcnt(14)
    v_lshlrev_b64 v[36:37], 16, v[76:77]
    v_exp_f32 v35, v31
    v_pk_fma_f32 v[16:17], v[16:17], v[32:33], v[16:17]
    v_pk_fma_f32 v[24:25], v[76:77], s[60:61], v[24:25]
    v_pk_fma_f32 v[18:19], v[18:19], v[34:35], v[18:19]
    v_pk_fma_f32 v[16:17], v[28:29], v[20:21], v[16:17]
    v_pk_fma_f32 v[26:27], v[36:37], s[60:61], v[26:27]
    v_pk_fma_f32 v[18:19], v[30:31], v[22:23], v[18:19]
    buffer_load_dword v76, v62, s[28:31], 0 offen sc1
    buffer_load_dword v77, v62, s[28:31], 0 offen offset:256 sc1
    v_pk_fma_f32 v[20:21], v[20:21], v[32:33], v[20:21]
    v_pk_fma_f32 v[22:23], v[22:23], v[34:35], v[22:23]
    v_exp_f32 v32, v24
    v_pk_fma_f32 v[28:29], v[8:9], v[54:55], v[12:13] op_sel:[0,1,0]
    v_exp_f32 v33, v25
    v_pk_fma_f32 v[30:31], v[10:11], v[54:55], v[14:15] op_sel:[0,1,0]
    v_exp_f32 v34, v26
    s_waitcnt vmcnt(14)
    v_lshlrev_b64 v[36:37], 16, v[78:79]
    v_exp_f32 v35, v27
    v_pk_fma_f32 v[16:17], v[16:17], v[32:33], v[16:17]
    v_pk_fma_f32 v[28:29], v[78:79], s[60:61], v[28:29]
    v_pk_fma_f32 v[18:19], v[18:19], v[34:35], v[18:19]
    v_pk_fma_f32 v[16:17], v[24:25], v[20:21], v[16:17]
    v_pk_fma_f32 v[30:31], v[36:37], s[60:61], v[30:31]
    v_pk_fma_f32 v[18:19], v[26:27], v[22:23], v[18:19]
    buffer_load_dword v78, v63, s[28:31], 0 offen sc1
    buffer_load_dword v79, v63, s[28:31], 0 offen offset:256 sc1
    s_waitcnt lgkmcnt(0)
    v_pk_add_f32 v[56:57], v[56:57], v[2:3] op_sel:[0,1]
    v_pk_add_f32 v[58:59], v[58:59], v[2:3] op_sel:[0,1]
    ds_read_b128 v[52:55], v41 offset:368
    v_pk_fma_f32 v[20:21], v[20:21], v[32:33], v[20:21]
    v_pk_fma_f32 v[22:23], v[22:23], v[34:35], v[22:23]
    v_exp_f32 v32, v28
    v_exp_f32 v33, v29
    v_exp_f32 v34, v30
    v_exp_f32 v35, v31
    v_pk_fma_f32 v[16:17], v[16:17], v[32:33], v[16:17]
    v_pk_fma_f32 v[18:19], v[18:19], v[34:35], v[18:19]
    v_pk_fma_f32 v[16:17], v[28:29], v[20:21], v[16:17]
    v_pk_fma_f32 v[18:19], v[30:31], v[22:23], v[18:19]
    v_pk_fma_f32 v[20:21], v[20:21], v[32:33], v[20:21]
    v_pk_fma_f32 v[22:23], v[22:23], v[34:35], v[22:23]
K_PEND:
    v_add_u32 v41, 32, v41
    s_lshr_b64 s[68:69], s[68:69], 8
    s_sub_u32 s70, s70, 8
    s_cmp_gt_u32 s70, 32
    s_cbranch_scc1 K_LOOP
    s_setprio 2
    s_cmp_gt_u32 s70, 21
    s_cbranch_scc1 K_LOOP
    s_setprio 1
    s_cmp_gt_u32 s70, 10
    s_cbranch_scc1 K_LOOP
    s_setprio 0
    s_cmp_ge_u32 s3, 8
    s_cbranch_scc1 K_LOOP
    s_cmp_eq_u32 s89, 0
    s_cbranch_scc1 K_LOOP
    s_mov_b32 s89, 0
    s_lshl_b32 s78, s3, 13
    s_add_u32 s78, s78, 0x710000
    s_add_u32 s79, s78, 4096
    buffer_load_dwordx4 v[96:99], v5, s[32:35], s78 offen offset:0 sc1
    buffer_load_dwordx4 v[100:103], v5, s[32:35], s78 offen offset:1024 sc1
    buffer_load_dwordx4 v[104:107], v5, s[32:35], s78 offen offset:2048 sc1
    buffer_load_dwordx4 v[108:111], v5, s[32:35], s78 offen offset:3072 sc1
    buffer_load_dwordx4 v[112:115], v5, s[32:35], s79 offen offset:0 sc1
    buffer_load_dwordx4 v[116:119], v5, s[32:35], s79 offen offset:1024 sc1
    buffer_load_dwordx4 v[120:123], v5, s[32:35], s79 offen offset:2048 sc1
    buffer_load_dwordx4 v[124:127], v5, s[32:35], s79 offen offset:3072 sc1
    s_branch K_LOOP
K_S0:
    s_bitcmp1_b32 s68, 0
    s_cbranch_scc1 K_H0
    v_pk_fma_f32 v[24:25], v[8:9], v[48:49], v[12:13] op_sel_hi:[1,0,1]
    v_pk_fma_f32 v[26:27], v[10:11], v[48:49], v[14:15] op_sel_hi:[1,0,1]
    s_waitcnt vmcnt(14)
    v_lshlrev_b64 v[36:37], 16, v[64:65]
    v_pk_fma_f32 v[24:25], v[64:65], s[60:61], v[24:25]
    v_pk_fma_f32 v[26:27], v[36:37], s[60:61], v[26:27]
    v_exp_f32 v32, v24
    v_exp_f32 v33, v25
    v_exp_f32 v34, v26
    v_exp_f32 v35, v27
    v_pk_fma_f32 v[16:17], v[16:17], v[32:33], v[16:17]
    v_pk_fma_f32 v[18:19], v[18:19], v[34:35], v[18:19]
    v_pk_fma_f32 v[16:17], v[24:25], v[20:21], v[16:17]
    v_pk_fma_f32 v[18:19], v[26:27], v[22:23], v[18:19]
    v_pk_fma_f32 v[20:21], v[20:21], v[32:33], v[20:21]
    v_pk_fma_f32 v[22:23], v[22:23], v[34:35], v[22:23]
K_J0:
    ds_read_b128 v[60:63], v41 offset:48
    buffer_load_dword v64, v56, s[28:31], 0 offen sc1
    buffer_load_dword v65, v56, s[28:31], 0 offen offset:256 sc1
K_S1:
    s_bitcmp1_b32 s68, 1
    s_cbranch_scc1 K_H1
    v_pk_fma_f32 v[24:25], v[8:9], v[48:49], v[12:13] op_sel:[0,1,0]
    v_pk_fma_f32 v[26:27], v[10:11], v[48:49], v[14:15] op_sel:[0,1,0]
    s_waitcnt vmcnt(14)
    v_lshlrev_b64 v[36:37], 16, v[66:67]
    v_pk_fma_f32 v[24:25], v[66:67], s[60:61], v[24:25]
    v_pk_fma_f32 v[26:27], v[36:37], s[60:61], v[26:27]
    v_exp_f32 v32, v24
    v_exp_f32 v33, v25
    v_exp_f32 v34, v26
    v_exp_f32 v35, v27
    v_pk_fma_f32 v[16:17], v[16:17], v[32:33], v[16:17]
    v_pk_fma_f32 v[18:19], v[18:19], v[34:35], v[18:19]
    v_pk_fma_f32 v[16:17], v[24:25], v[20:21], v[16:17]
    v_pk_fma_f32 v[18:19], v[26:27], v[22:23], v[18:19]
    v_pk_fma_f32 v[20:21], v[20:21], v[32:33], v[20:21]
    v_pk_fma_f32 v[22:23], v[22:23], v[34:35], v[22:23]
K_J1:
    buffer_load_dword v66, v57, s[28:31], 0 offen sc1
    buffer_load_dword v67, v57, s[28:31], 0 offen offset:256 sc1
K_S2:
    s_bitcmp1_b32 s68, 2
    s_cbranch_scc1 K_H2
    v_pk_fma_f32 v[24:25], v[8:9], v[50:51], v[12:13] op_sel_hi:[1,0,1]
    v_pk_fma_f32 v[26:27], v[10:11], v[50:51], v[14:15] op_sel_hi:[1,0,1]
    s_waitcnt vmcnt(14)
    v_lshlrev_b64 v[36:37], 16, v[68:69]
    v_pk_fma_f32 v[24:25], v[68:69], s[60:61], v[24:25]
    v_pk_fma_f32 v[26:27], v[36:37], s[60:61], v[26:27]
    v_exp_f32 v32, v24
    v_exp_f32 v33, v25
    v_exp_f32 v34, v26
    v_exp_f32 v35, v27
    v_pk_fma_f32 v[16:17], v[16:17], v[32:33], v[16:17]
    v_pk_fma_f32 v[18:19], v[18:19], v[34:35], v[18:19]
    v_pk_fma_f32 v[16:17], v[24:25], v[20:21], v[16:17]
    v_pk_fma_f32 v[18:19], v[26:27], v[22:23], v[18:19]
    v_pk_fma_f32 v[20:21], v[20:21], v[32:33], v[20:21]
    v_pk_fma_f32 v[22:23], v[22:23], v[34:35], v[22:23]
K_J2:
    buffer_load_dword v68, v58, s[28:31], 0 offen sc1
    buffer_load_dword v69, v58, s[28:31], 0 offen offset:256 sc1
K_S3:
    s_bitcmp1_b32 s68, 3
    s_cbranch_scc1 K_H3
    v_pk_fma_f32 v[24:25], v[8:9], v[50:51], v[12:13] op_sel:[0,1,0]
    v_pk_fma_f32 v[26:27], v[10:11], v[50:51], v[14:15] op_sel:[0,1,0]
    s_waitcnt vmcnt(14)
    v_lshlrev_b64 v[36:37], 16, v[70:71]
    v_pk_fma_f32 v[24:25], v[70:71], s[60:61], v[24:25]
    v_pk_fma_f32 v[26:27], v[36:37], s[60:61], v[26:27]
    v_exp_f32 v32, v24
    v_exp_f32 v33, v25
    v_exp_f32 v34, v26
    v_exp_f32 v35, v27
    v_pk_fma_f32 v[16:17], v[16:17], v[32:33], v[16:17]
    v_pk_fma_f32 v[18:19], v[18:19], v[34:35], v[18:19]
    v_pk_fma_f32 v[16:17], v[24:25], v[20:21], v[16:17]
    v_pk_fma_f32 v[18:19], v[26:27], v[22:23], v[18:19]
    v_pk_fma_f32 v[20:21], v[20:21], v[32:33], v[20:21]
    v_pk_fma_f32 v[22:23], v[22:23], v[34:35], v[22:23]
K_J3:
    buffer_load_dword v70, v59, s[28:31], 0 offen sc1
    buffer_load_dword v71, v59, s[28:31], 0 offen offset:256 sc1
    s_waitcnt lgkmcnt(0)
    v_pk_add_f32 v[60:61], v[60:61], v[2:3] op_sel:[0,1]
    v_pk_add_f32 v[62:63], v[62:63], v[2:3] op_sel:[0,1]
    ds_read_b128 v[48:51], v41 offset:352
    s_branch K_G1
K_S4:
    s_bitcmp1_b32 s68, 4
    s_cbranch_scc1 K_H4
    v_pk_fma_f32 v[24:25], v[8:9], v[52:53], v[12:13] op_sel_hi:[1,0,1]
    v_pk_fma_f32 v[26:27], v[10:11], v[52:53], v[14:15] op_sel_hi:[1,0,1]
    s_waitcnt vmcnt(14)
    v_lshlrev_b64 v[36:37], 16, v[72:73]
    v_pk_fma_f32 v[24:25], v[72:73], s[60:61], v[24:25]
    v_pk_fma_f32 v[26:27], v[36:37], s[60:61], v[26:27]
    v_exp_f32 v32, v24
    v_exp_f32 v33, v25
    v_exp_f32 v34, v26
    v_exp_f32 v35, v27
    v_pk_fma_f32 v[16:17], v[16:17], v[32:33], v[16:17]
    v_pk_fma_f32 v[18:19], v[18:19], v[34:35], v[18:19]
    v_pk_fma_f32 v[16:17], v[24:25], v[20:21], v[16:17]
    v_pk_fma_f32 v[18:19], v[26:27], v[22:23], v[18:19]
    v_pk_fma_f32 v[20:21], v[20:21], v[32:33], v[20:21]
    v_pk_fma_f32 v[22:23], v[22:23], v[34:35], v[22:23]
K_J4:
    ds_read_b128 v[56:59], v41 offset:64
    buffer_load_dword v72, v60, s[28:31], 0 offen sc1
    buffer_load_dword v73, v60, s[28:31], 0 offen offset:256 sc1
K_S5:
    s_bitcmp1_b32 s68, 5
    s_cbranch_scc1 K_H5
    v_pk_fma_f32 v[24:25], v[8:9], v[52:53], v[12:13] op_sel:[0,1,0]
    v_pk_fma_f32 v[26:27], v[10:11], v[52:53], v[14:15] op_sel:[0,1,0]
    s_waitcnt vmcnt(14)
    v_lshlrev_b64 v[36:37], 16, v[74:75]
    v_pk_fma_f32 v[24:25], v[74:75], s[60:61], v[24:25]
    v_pk_fma_f32 v[26:27], v[36:37], s[60:61], v[26:27]
    v_exp_f32 v32, v24
    v_exp_f32 v33, v25
    v_exp_f32 v34, v26
    v_exp_f32 v35, v27
    v_pk_fma_f32 v[16:17], v[16:17], v[32:33], v[16:17]
    v_pk_fma_f32 v[18:19], v[18:19], v[34:35], v[18:19]
    v_pk_fma_f32 v[16:17], v[24:25], v[20:21], v[16:17]
    v_pk_fma_f32 v[18:19], v[26:27], v[22:23], v[18:19]
    v_pk_fma_f32 v[20:21], v[20:21], v[32:33], v[20:21]
    v_pk_fma_f32 v[22:23], v[22:23], v[34:35], v[22:23]
K_J5:
    buffer_load_dword v74, v61, s[28:31], 0 offen sc1
    buffer_load_dword v75, v61, s[28:31], 0 offen offset:256 sc1
K_S6:
    s_bitcmp1_b32 s68, 6
    s_cbranch_scc1 K_H6
    v_pk_fma_f32 v[24:25], v[8:9], v[54:55], v[12:13] op_sel_hi:[1,0,1]
    v_pk_fma_f32 v[26:27], v[10:11], v[54:55], v[14:15] op_sel_hi:[1,0,1]
    s_waitcnt vmcnt(14)
    v_lshlrev_b64 v[36:37], 16, v[76:77]
    v_pk_fma_f32 v[24:25], v[76:77], s[60:61], v[24:25]
    v_pk_fma_f32 v[26:27], v[36:37], s[60:61], v[26:27]
    v_exp_f32 v32, v24
    v_exp_f32 v33, v25
    v_exp_f32 v34, v26
    v_exp_f32 v35, v27
    v_pk_fma_f32 v[16:17], v[16:17], v[32:33], v[16:17]
    v_pk_fma_f32 v[18:19], v[18:19], v[34:35], v[18:19]
    v_pk_fma_f32 v[16:17], v[24:25], v[20:21], v[16:17]
    v_pk_fma_f32 v[18:19], v[26:27], v[22:23], v[18:19]
    v_pk_fma_f32 v[20:21], v[20:21], v[32:33], v[20:21]
    v_pk_fma_f32 v[22:23], v[22:23], v[34:35], v[22:23]
K_J6:
    buffer_load_dword v76, v62, s[28:31], 0 offen sc1
    buffer_load_dword v77, v62, s[28:31], 0 offen offset:256 sc1
K_S7:
    s_bitcmp1_b32 s68, 7
    s_cbranch_scc1 K_H7
    v_pk_fma_f32 v[24:25], v[8:9], v[54:55], v[12:13] op_sel:[0,1,0]
    v_pk_fma_f32 v[26:27], v[10:11], v[54:55], v[14:15] op_sel:[0,1,0]
    s_waitcnt vmcnt(14)
    v_lshlrev_b64 v[36:37], 16, v[78:79]
    v_pk_fma_f32 v[24:25], v[78:79], s[60:61], v[24:25]
    v_pk_fma_f32 v[26:27], v[36:37], s[60:61], v[26:27]
    v_exp_f32 v32, v24
    v_exp_f32 v33, v25
    v_exp_f32 v34, v26
    v_exp_f32 v35, v27
    v_pk_fma_f32 v[16:17], v[16:17], v[32:33], v[16:17]
    v_pk_fma_f32 v[18:19], v[18:19], v[34:35], v[18:19]
    v_pk_fma_f32 v[16:17], v[24:25], v[20:21], v[16:17]
    v_pk_fma_f32 v[18:19], v[26:27], v[22:23], v[18:19]
    v_pk_fma_f32 v[20:21], v[20:21], v[32:33], v[20:21]
    v_pk_fma_f32 v[22:23], v[22:23], v[34:35], v[22:23]
K_J7:
    buffer_load_dword v78, v63, s[28:31], 0 offen sc1
    buffer_load_dword v79, v63, s[28:31], 0 offen offset:256 sc1
    s_waitcnt lgkmcnt(0)
    v_pk_add_f32 v[56:57], v[56:57], v[2:3] op_sel:[0,1]
    v_pk_add_f32 v[58:59], v[58:59], v[2:3] op_sel:[0,1]
    ds_read_b128 v[52:55], v41 offset:368
    s_branch K_PEND
K_H0:
    s_cmp_eq_u32 s70, 0
    s_cbranch_scc1 K_LAST
    v_and_b32 v36, 0xfc, v48
    v_mad_u32_u24 v37, v36, s80, v7
    ds_read_b128 v[12:15], v37
    v_rcp_f32 v32, v20
    v_rcp_f32 v33, v21
    v_rcp_f32 v34, v22
    v_rcp_f32 v35, v23
    v_pk_fma_f32 v[38:39], v[20:21], v[16:17], v[38:39]
    v_pk_fma_f32 v[38:39], v[22:23], v[18:19], v[38:39]
    v_pk_mul_f32 v[24:25], v[16:17], v[32:33]
    v_pk_mul_f32 v[26:27], v[18:19], v[34:35]
    s_cmp_lg_u32 s72, 0
    s_cbranch_scc1 K_LS0
    v_cvt_pk_bf16_f32 v24, v24, v25
    v_cvt_pk_bf16_f32 v25, v26, v27
    ds_write_b64 v40, v[24:25]
K_HC0:
    v_mad_u32_u24 v40, v36, s81, v4
    s_waitcnt vmcnt(14) lgkmcnt(0)
    v_pk_fma_f32 v[24:25], v[8:9], v[48:49], v[12:13] op_sel_hi:[1,0,1]
    v_pk_fma_f32 v[26:27], v[10:11], v[48:49], v[14:15] op_sel_hi:[1,0,1]
    v_lshlrev_b64 v[36:37], 16, v[64:65]
    v_pk_fma_f32 v[16:17], v[64:65], s[60:61], v[24:25]
    v_pk_fma_f32 v[18:19], v[36:37], s[60:61], v[26:27]
    v_exp_f32 v32, v16
    v_exp_f32 v33, v17
    v_exp_f32 v34, v18
    v_exp_f32 v35, v19
    v_pk_add_f32 v[20:21], v[32:33], 1.0 op_sel_hi:[1,0]
    v_pk_add_f32 v[22:23], v[34:35], 1.0 op_sel_hi:[1,0]
    s_branch K_J0
K_LS0:
    v_add_u32 v28, s85, v5
    s_lshl_b32 s78, s3, 2
    v_mov_b32 v29, s78
    v_mov_b32 v30, 1
    ds_write_b128 v28, v[24:27]
    ds_write_b32 v29, v30 offset:272
    s_mov_b32 s72, 0
    s_branch K_HC0
K_H1:
    s_cmp_eq_u32 s70, 1
    s_cbranch_scc1 K_LAST
    v_and_b32 v36, 0xfc, v49
    v_mad_u32_u24 v37, v36, s80, v7
    ds_read_b128 v[12:15], v37
    v_rcp_f32 v32, v20
    v_rcp_f32 v33, v21
    v_rcp_f32 v34, v22
    v_rcp_f32 v35, v23
    v_pk_fma_f32 v[38:39], v[20:21], v[16:17], v[38:39]
    v_pk_fma_f32 v[38:39], v[22:23], v[18:19], v[38:39]
    v_pk_mul_f32 v[24:25], v[16:17], v[32:33]
    v_pk_mul_f32 v[26:27], v[18:19], v[34:35]
    s_cmp_lg_u32 s72, 0
    s_cbranch_scc1 K_LS1
    v_cvt_pk_bf16_f32 v24, v24, v25
    v_cvt_pk_bf16_f32 v25, v26, v27
    ds_write_b64 v40, v[24:25]
K_HC1:
    v_mad_u32_u24 v40, v36, s81, v4
    s_waitcnt vmcnt(14) lgkmcnt(0)
    v_pk_fma_f32 v[24:25], v[8:9], v[48:49], v[12:13] op_sel:[0,1,0]
    v_pk_fma_f32 v[26:27], v[10:11], v[48:49], v[14:15] op_sel:[0,1,0]
    v_lshlrev_b64 v[36:37], 16, v[66:67]
    v_pk_fma_f32 v[16:17], v[66:67], s[60:61], v[24:25]
    v_pk_fma_f32 v[18:19], v[36:37], s[60:61], v[26:27]
    v_exp_f32 v32, v16
    v_exp_f32 v33, v17
    v_exp_f32 v34, v18
    v_exp_f32 v35, v19
    v_pk_add_f32 v[20:21], v[32:33], 1.0 op_sel_hi:[1,0]
    v_pk_add_f32 v[22:23], v[34:35], 1.0 op_sel_hi:[1,0]
    s_branch K_J1
K_LS1:
    v_add_u32 v28, s85, v5
    s_lshl_b32 s78, s3, 2
    v_mov_b32 v29, s78
    v_mov_b32 v30, 1
    ds_write_b128 v28, v[24:27]
    ds_write_b32 v29, v30 offset:272
    s_mov_b32 s72, 0
    s_branch K_HC1
K_H2:
    s_cmp_eq_u32 s70, 2
    s_cbranch_scc1 K_LAST
    v_and_b32 v36, 0xfc, v50
    v_mad_u32_u24 v37, v36, s80, v7
    ds_read_b128 v[12:15], v37
    v_rcp_f32 v32, v20
    v_rcp_f32 v33, v21
    v_rcp_f32 v34, v22
    v_rcp_f32 v35, v23
    v_pk_fma_f32 v[38:39], v[20:21], v[16:17], v[38:39]
    v_pk_fma_f32 v[38:39], v[22:23], v[18:19], v[38:39]
    v_pk_mul_f32 v[24:25], v[16:17], v[32:33]
    v_pk_mul_f32 v[26:27], v[18:19], v[34:35]
    s_cmp_lg_u32 s72, 0
    s_cbranch_scc1 K_LS2
    v_cvt_pk_bf16_f32 v24, v24, v25
    v_cvt_pk_bf16_f32 v25, v26, v27
    ds_write_b64 v40, v[24:25]
K_HC2:
    v_mad_u32_u24 v40, v36, s81, v4
    s_waitcnt vmcnt(14) lgkmcnt(0)
    v_pk_fma_f32 v[24:25], v[8:9], v[50:51], v[12:13] op_sel_hi:[1,0,1]
    v_pk_fma_f32 v[26:27], v[10:11], v[50:51], v[14:15] op_sel_hi:[1,0,1]
    v_lshlrev_b64 v[36:37], 16, v[68:69]
    v_pk_fma_f32 v[16:17], v[68:69], s[60:61], v[24:25]
    v_pk_fma_f32 v[18:19], v[36:37], s[60:61], v[26:27]
    v_exp_f32 v32, v16
    v_exp_f32 v33, v17
    v_exp_f32 v34, v18
    v_exp_f32 v35, v19
    v_pk_add_f32 v[20:21], v[32:33], 1.0 op_sel_hi:[1,0]
    v_pk_add_f32 v[22:23], v[34:35], 1.0 op_sel_hi:[1,0]
    s_branch K_J2
K_LS2:
    v_add_u32 v28, s85, v5
    s_lshl_b32 s78, s3, 2
    v_mov_b32 v29, s78
    v_mov_b32 v30, 1
    ds_write_b128 v28, v[24:27]
    ds_write_b32 v29, v30 offset:272
    s_mov_b32 s72, 0
    s_branch K_HC2
K_H3:
    s_cmp_eq_u32 s70, 3
    s_cbranch_scc1 K_LAST
    v_and_b32 v36, 0xfc, v51
    v_mad_u32_u24 v37, v36, s80, v7
    ds_read_b128 v[12:15], v37
    v_rcp_f32 v32, v20
    v_rcp_f32 v33, v21
    v_rcp_f32 v34, v22
    v_rcp_f32 v35, v23
    v_pk_fma_f32 v[38:39], v[20:21], v[16:17], v[38:39]
    v_pk_fma_f32 v[38:39], v[22:23], v[18:19], v[38:39]
    v_pk_mul_f32 v[24:25], v[16:17], v[32:33]
    v_pk_mul_f32 v[26:27], v[18:19], v[34:35]
    s_cmp_lg_u32 s72, 0
    s_cbranch_scc1 K_LS3
    v_cvt_pk_bf16_f32 v24, v24, v25
    v_cvt_pk_bf16_f32 v25, v26, v27
    ds_write_b64 v40, v[24:25]
K_HC3:
    v_mad_u32_u24 v40, v36, s81, v4
    s_waitcnt vmcnt(14) lgkmcnt(0)
    v_pk_fma_f32 v[24:25], v[8:9], v[50:51], v[12:13] op_sel:[0,1,0]
    v_pk_fma_f32 v[26:27], v[10:11], v[50:51], v[14:15] op_sel:[0,1,0]
    v_lshlrev_b64 v[36:37], 16, v[70:71]
    v_pk_fma_f32 v[16:17], v[70:71], s[60:61], v[24:25]
    v_pk_fma_f32 v[18:19], v[36:37], s[60:61], v[26:27]
    v_exp_f32 v32, v16
    v_exp_f32 v33, v17
    v_exp_f32 v34, v18
    v_exp_f32 v35, v19
    v_pk_add_f32 v[20:21], v[32:33], 1.0 op_sel_hi:[1,0]
    v_pk_add_f32 v[22:23], v[34:35], 1.0 op_sel_hi:[1,0]
    s_branch K_J3
K_LS3:
    v_add_u32 v28, s85, v5
    s_lshl_b32 s78, s3, 2
    v_mov_b32 v29, s78
    v_mov_b32 v30, 1
    ds_write_b128 v28, v[24:27]
    ds_write_b32 v29, v30 offset:272
    s_mov_b32 s72, 0
    s_branch K_HC3
K_H4:
    s_cmp_eq_u32 s70, 4
    s_cbranch_scc1 K_LAST
    v_and_b32 v36, 0xfc, v52
    v_mad_u32_u24 v37, v36, s80, v7
    ds_read_b128 v[12:15], v37
    v_rcp_f32 v32, v20
    v_rcp_f32 v33, v21
    v_rcp_f32 v34, v22
    v_rcp_f32 v35, v23
    v_pk_fma_f32 v[38:39], v[20:21], v[16:17], v[38:39]
    v_pk_fma_f32 v[38:39], v[22:23], v[18:19], v[38:39]
    v_pk_mul_f32 v[24:25], v[16:17], v[32:33]
    v_pk_mul_f32 v[26:27], v[18:19], v[34:35]
    s_cmp_lg_u32 s72, 0
    s_cbranch_scc1 K_LS4
    v_cvt_pk_bf16_f32 v24, v24, v25
    v_cvt_pk_bf16_f32 v25, v26, v27
    ds_write_b64 v40, v[24:25]
K_HC4:
    v_mad_u32_u24 v40, v36, s81, v4
    s_waitcnt vmcnt(14) lgkmcnt(0)
    v_pk_fma_f32 v[24:25], v[8:9], v[52:53], v[12:13] op_sel_hi:[1,0,1]
    v_pk_fma_f32 v[26:27], v[10:11], v[52:53], v[14:15] op_sel_hi:[1,0,1]
    v_lshlrev_b64 v[36:37], 16, v[72:73]
    v_pk_fma_f32 v[16:17], v[72:73], s[60:61], v[24:25]
    v_pk_fma_f32 v[18:19], v[36:37], s[60:61], v[26:27]
    v_exp_f32 v32, v16
    v_exp_f32 v33, v17
    v_exp_f32 v34, v18
    v_exp_f32 v35, v19
    v_pk_add_f32 v[20:21], v[32:33], 1.0 op_sel_hi:[1,0]
    v_pk_add_f32 v[22:23], v[34:35], 1.0 op_sel_hi:[1,0]
    s_branch K_J4
K_LS4:
    v_add_u32 v28, s85, v5
    s_lshl_b32 s78, s3, 2
    v_mov_b32 v29, s78
    v_mov_b32 v30, 1
    ds_write_b128 v28, v[24:27]
    ds_write_b32 v29, v30 offset:272
    s_mov_b32 s72, 0
    s_branch K_HC4
K_H5:
    s_cmp_eq_u32 s70, 5
    s_cbranch_scc1 K_LAST
    v_and_b32 v36, 0xfc, v53
    v_mad_u32_u24 v37, v36, s80, v7
    ds_read_b128 v[12:15], v37
    v_rcp_f32 v32, v20
    v_rcp_f32 v33, v21
    v_rcp_f32 v34, v22
    v_rcp_f32 v35, v23
    v_pk_fma_f32 v[38:39], v[20:21], v[16:17], v[38:39]
    v_pk_fma_f32 v[38:39], v[22:23], v[18:19], v[38:39]
    v_pk_mul_f32 v[24:25], v[16:17], v[32:33]
    v_pk_mul_f32 v[26:27], v[18:19], v[34:35]
    s_cmp_lg_u32 s72, 0
    s_cbranch_scc1 K_LS5
    v_cvt_pk_bf16_f32 v24, v24, v25
    v_cvt_pk_bf16_f32 v25, v26, v27
    ds_write_b64 v40, v[24:25]
K_HC5:
    v_mad_u32_u24 v40, v36, s81, v4
    s_waitcnt vmcnt(14) lgkmcnt(0)
    v_pk_fma_f32 v[24:25], v[8:9], v[52:53], v[12:13] op_sel:[0,1,0]
    v_pk_fma_f32 v[26:27], v[10:11], v[52:53], v[14:15] op_sel:[0,1,0]
    v_lshlrev_b64 v[36:37], 16, v[74:75]
    v_pk_fma_f32 v[16:17], v[74:75], s[60:61], v[24:25]
    v_pk_fma_f32 v[18:19], v[36:37], s[60:61], v[26:27]
    v_exp_f32 v32, v16
    v_exp_f32 v33, v17
    v_exp_f32 v34, v18
    v_exp_f32 v35, v19
    v_pk_add_f32 v[20:21], v[32:33], 1.0 op_sel_hi:[1,0]
    v_pk_add_f32 v[22:23], v[34:35], 1.0 op_sel_hi:[1,0]
    s_branch K_J5
K_LS5:
    v_add_u32 v28, s85, v5
    s_lshl_b32 s78, s3, 2
    v_mov_b32 v29, s78
    v_mov_b32 v30, 1
    ds_write_b128 v28, v[24:27]
    ds_write_b32 v29, v30 offset:272
    s_mov_b32 s72, 0
    s_branch K_HC5
K_H6:
    s_cmp_eq_u32 s70, 6
    s_cbranch_scc1 K_LAST
    v_and_b32 v36, 0xfc, v54
    v_mad_u32_u24 v37, v36, s80, v7
    ds_read_b128 v[12:15], v37
    v_rcp_f32 v32, v20
    v_rcp_f32 v33, v21
    v_rcp_f32 v34, v22
    v_rcp_f32 v35, v23
    v_pk_fma_f32 v[38:39], v[20:21], v[16:17], v[38:39]
    v_pk_fma_f32 v[38:39], v[22:23], v[18:19], v[38:39]
    v_pk_mul_f32 v[24:25], v[16:17], v[32:33]
    v_pk_mul_f32 v[26:27], v[18:19], v[34:35]
    s_cmp_lg_u32 s72, 0
    s_cbranch_scc1 K_LS6
    v_cvt_pk_bf16_f32 v24, v24, v25
    v_cvt_pk_bf16_f32 v25, v26, v27
    ds_write_b64 v40, v[24:25]
K_HC6:
    v_mad_u32_u24 v40, v36, s81, v4
    s_waitcnt vmcnt(14) lgkmcnt(0)
    v_pk_fma_f32 v[24:25], v[8:9], v[54:55], v[12:13] op_sel_hi:[1,0,1]
    v_pk_fma_f32 v[26:27], v[10:11], v[54:55], v[14:15] op_sel_hi:[1,0,1]
    v_lshlrev_b64 v[36:37], 16, v[76:77]
    v_pk_fma_f32 v[16:17], v[76:77], s[60:61], v[24:25]
    v_pk_fma_f32 v[18:19], v[36:37], s[60:61], v[26:27]
    v_exp_f32 v32, v16
    v_exp_f32 v33, v17
    v_exp_f32 v34, v18
    v_exp_f32 v35, v19
    v_pk_add_f32 v[20:21], v[32:33], 1.0 op_sel_hi:[1,0]
    v_pk_add_f32 v[22:23], v[34:35], 1.0 op_sel_hi:[1,0]
    s_branch K_J6
K_LS6:
    v_add_u32 v28, s85, v5
    s_lshl_b32 s78, s3, 2
    v_mov_b32 v29, s78
    v_mov_b32 v30, 1
    ds_write_b128 v28, v[24:27]
    ds_write_b32 v29, v30 offset:272
    s_mov_b32 s72, 0
    s_branch K_HC6
K_H7:
    s_cmp_eq_u32 s70, 7
    s_cbranch_scc1 K_LAST
    v_and_b32 v36, 0xfc, v55
    v_mad_u32_u24 v37, v36, s80, v7
    ds_read_b128 v[12:15], v37
    v_rcp_f32 v32, v20
    v_rcp_f32 v33, v21
    v_rcp_f32 v34, v22
    v_rcp_f32 v35, v23
    v_pk_fma_f32 v[38:39], v[20:21], v[16:17], v[38:39]
    v_pk_fma_f32 v[38:39], v[22:23], v[18:19], v[38:39]
    v_pk_mul_f32 v[24:25], v[16:17], v[32:33]
    v_pk_mul_f32 v[26:27], v[18:19], v[34:35]
    s_cmp_lg_u32 s72, 0
    s_cbranch_scc1 K_LS7
    v_cvt_pk_bf16_f32 v24, v24, v25
    v_cvt_pk_bf16_f32 v25, v26, v27
    ds_write_b64 v40, v[24:25]
K_HC7:
    v_mad_u32_u24 v40, v36, s81, v4
    s_waitcnt vmcnt(14) lgkmcnt(0)
    v_pk_fma_f32 v[24:25], v[8:9], v[54:55], v[12:13] op_sel:[0,1,0]
    v_pk_fma_f32 v[26:27], v[10:11], v[54:55], v[14:15] op_sel:[0,1,0]
    v_lshlrev_b64 v[36:37], 16, v[78:79]
    v_pk_fma_f32 v[16:17], v[78:79], s[60:61], v[24:25]
    v_pk_fma_f32 v[18:19], v[36:37], s[60:61], v[26:27]
    v_exp_f32 v32, v16
    v_exp_f32 v33, v17
    v_exp_f32 v34, v18
    v_exp_f32 v35, v19
    v_pk_add_f32 v[20:21], v[32:33], 1.0 op_sel_hi:[1,0]
    v_pk_add_f32 v[22:23], v[34:35], 1.0 op_sel_hi:[1,0]
    s_branch K_J7
K_LS7:
    v_add_u32 v28, s85, v5
    s_lshl_b32 s78, s3, 2
    v_mov_b32 v29, s78
    v_mov_b32 v30, 1
    ds_write_b128 v28, v[24:27]
    ds_write_b32 v29, v30 offset:272
    s_mov_b32 s72, 0
    s_branch K_HC7
K_LAST:
    s_lshl_b32 s78, s3, 2
    v_mov_b32 v36, s78
    v_add_u32 v37, s85, v5
    ds_read_b32 v28, v36 offset:276
    ds_read_b128 v[12:15], v37 offset:1024
    v_rcp_f32 v32, v20
    v_rcp_f32 v33, v21
    v_rcp_f32 v34, v22
    v_rcp_f32 v35, v23
    v_pk_fma_f32 v[38:39], v[20:21], v[16:17], v[38:39]
    v_pk_fma_f32 v[38:39], v[22:23], v[18:19], v[38:39]
    v_pk_mul_f32 v[24:25], v[16:17], v[32:33]
    v_pk_mul_f32 v[26:27], v[18:19], v[34:35]
    s_cmp_eq_u32 s72, 0
    s_cbranch_scc1 K_L1
    s_waitcnt lgkmcnt(0)
    v_add_u32 v28, s85, v5
    s_lshl_b32 s78, s3, 2
    v_mov_b32 v29, s78
    v_mov_b32 v30, 1
    ds_write_b128 v28, v[24:27]
    ds_write_b32 v29, v30 offset:272
    s_mov_b32 s72, 0
    s_branch K_WDONE
K_L1:
    s_cmp_eq_u32 s84, 0
    s_cbranch_scc1 K_L3
    s_mov_b32 s67, 65536
K_L2:
    s_waitcnt lgkmcnt(0)
    v_readfirstlane_b32 s78, v28
    s_cmp_lg_u32 s78, 0
    s_cbranch_scc1 K_L2B
    s_sub_u32 s67, s67, 1
    s_cbranch_scc1 K_L2B
    s_sleep 2
    ds_read_b32 v28, v36 offset:276
    ds_read_b128 v[12:15], v37 offset:1024
    s_branch K_L2
K_L2B:
    v_pk_add_f32 v[24:25], v[24:25], v[12:13]
    v_pk_add_f32 v[26:27], v[26:27], v[14:15]
K_L3:
    v_cvt_pk_bf16_f32 v24, v24, v25
    v_cvt_pk_bf16_f32 v25, v26, v27
    ds_write_b64 v40, v[24:25]
K_WDONE:
    v_add_f32 v32, v38, v39
    v_mov_b32 v29, 0x207
    v_cmp_class_f32 vcc, v32, v29
    v_mov_b32 v30, 0
    s_mov_b32 s82, 0xbf317218
    s_xor_b32 s78, s3, 15
    s_or_b32 s78, s78, s2
    s_cbranch_scc1 K_NOCLR
    s_mov_b32 s36, s22
    s_and_b32 s37, s23, 0xffff
    s_mov_b32 s38, 0x100
    s_mov_b32 s39, 0x20000
    buffer_store_dword v30, v2, s[36:39], 0 offen sc1
K_NOCLR:
    s_mov_b32 s36, s20
    s_and_b32 s37, s21, 0xffff
    s_mov_b32 s38, 0x271000
    s_mov_b32 s39, 0x20000
    s_cbranch_vccz K_NOG
    ds_write_b32 v30, v29 offset:264
K_NOG:
    s_cmp_ge_u32 s3, 8
    s_cbranch_scc1 K_B4
    s_cmp_eq_u32 s89, 0
    s_cbranch_scc1 K_B4
    s_mov_b32 s89, 0
    s_lshl_b32 s78, s3, 13
    s_add_u32 s78, s78, 0x710000
    s_add_u32 s79, s78, 4096
    buffer_load_dwordx4 v[96:99], v5, s[32:35], s78 offen offset:0 sc1
    buffer_load_dwordx4 v[100:103], v5, s[32:35], s78 offen offset:1024 sc1
    buffer_load_dwordx4 v[104:107], v5, s[32:35], s78 offen offset:2048 sc1
    buffer_load_dwordx4 v[108:111], v5, s[32:35], s78 offen offset:3072 sc1
    buffer_load_dwordx4 v[112:115], v5, s[32:35], s79 offen offset:0 sc1
    buffer_load_dwordx4 v[116:119], v5, s[32:35], s79 offen offset:1024 sc1
    buffer_load_dwordx4 v[120:123], v5, s[32:35], s79 offen offset:2048 sc1
    buffer_load_dwordx4 v[124:127], v5, s[32:35], s79 offen offset:3072 sc1
K_B4:
    s_waitcnt vmcnt(0) lgkmcnt(0)
    s_barrier
    ds_read_b32 v31, v30 offset:264
    s_cmp_ge_u32 s3, 8
    s_cbranch_scc1 K_CHK
    ds_read_b128 v[48:51], v80 offset:0
    ds_read_b128 v[52:55], v80 offset:64
    ds_read_b128 v[56:59], v80 offset:128
    ds_read_b128 v[60:63], v80 offset:192
    ds_read_b128 v[64:67], v80 offset:256
    ds_read_b128 v[68:71], v80 offset:320
    ds_read_b128 v[72:75], v80 offset:384
    ds_read_b128 v[76:79], v80 offset:448
    s_waitcnt lgkmcnt(7)
    v_mfma_f32_16x16x32_bf16 v[12:15], v[96:99], v[48:51], 0
    ds_read_b128 v[48:51], v81 offset:0
    s_waitcnt lgkmcnt(7)
    v_mfma_f32_16x16x32_bf16 v[12:15], v[100:103], v[52:55], v[12:15]
    ds_read_b128 v[52:55], v81 offset:64
    s_waitcnt lgkmcnt(7)
    v_mfma_f32_16x16x32_bf16 v[12:15], v[104:107], v[56:59], v[12:15]
    ds_read_b128 v[56:59], v81 offset:128
    s_waitcnt lgkmcnt(7)
    v_mfma_f32_16x16x32_bf16 v[12:15], v[108:111], v[60:63], v[12:15]
    ds_read_b128 v[60:63], v81 offset:192
    s_waitcnt lgkmcnt(7)
    v_mfma_f32_16x16x32_bf16 v[12:15], v[112:115], v[64:67], v[12:15]
    ds_read_b128 v[64:67], v81 offset:256
    s_waitcnt lgkmcnt(7)
    v_mfma_f32_16x16x32_bf16 v[12:15], v[116:119], v[68:71], v[12:15]
    ds_read_b128 v[68:71], v81 offset:320
    s_waitcnt lgkmcnt(7)
    v_mfma_f32_16x16x32_bf16 v[12:15], v[120:123], v[72:75], v[12:15]
    ds_read_b128 v[72:75], v81 offset:384
    s_waitcnt lgkmcnt(7)
    v_mfma_f32_16x16x32_bf16 v[12:15], v[124:127], v[76:79], v[12:15]
    ds_read_b128 v[76:79], v81 offset:448
    s_waitcnt lgkmcnt(7)
    v_mfma_f32_16x16x32_bf16 v[16:19], v[96:99], v[48:51], 0
    ds_read_b128 v[48:51], v82 offset:0
    s_waitcnt lgkmcnt(7)
    v_mfma_f32_16x16x32_bf16 v[16:19], v[100:103], v[52:55], v[16:19]
    ds_read_b128 v[52:55], v82 offset:64
    s_waitcnt lgkmcnt(7)
    v_mfma_f32_16x16x32_bf16 v[16:19], v[104:107], v[56:59], v[16:19]
    ds_read_b128 v[56:59], v82 offset:128
    s_waitcnt lgkmcnt(7)
    v_mfma_f32_16x16x32_bf16 v[16:19], v[108:111], v[60:63], v[16:19]
    ds_read_b128 v[60:63], v82 offset:192
    s_waitcnt lgkmcnt(7)
    v_mfma_f32_16x16x32_bf16 v[16:19], v[112:115], v[64:67], v[16:19]
    v_fma_f32 v84, v12, s82, v84
    v_fma_f32 v85, v13, s82, v85
    v_fma_f32 v86, v14, s82, v86
    v_fma_f32 v87, v15, s82, v87
    v_cvt_pk_bf16_f32 v32, v84, v85
    v_cvt_pk_bf16_f32 v33, v86, v87
    ds_read_b128 v[64:67], v82 offset:256
    s_waitcnt lgkmcnt(7)
    v_mfma_f32_16x16x32_bf16 v[16:19], v[116:119], v[68:71], v[16:19]
    ds_read_b128 v[68:71], v82 offset:320
    s_waitcnt lgkmcnt(7)
    v_mfma_f32_16x16x32_bf16 v[16:19], v[120:123], v[72:75], v[16:19]
    ds_read_b128 v[72:75], v82 offset:384
    s_waitcnt lgkmcnt(7)
    v_mfma_f32_16x16x32_bf16 v[16:19], v[124:127], v[76:79], v[16:19]
    ds_read_b128 v[76:79], v82 offset:448
    s_waitcnt lgkmcnt(7)
    v_mfma_f32_16x16x32_bf16 v[20:23], v[96:99], v[48:51], 0
    s_waitcnt lgkmcnt(6)
    v_mfma_f32_16x16x32_bf16 v[20:23], v[100:103], v[52:55], v[20:23]
    s_waitcnt lgkmcnt(5)
    v_mfma_f32_16x16x32_bf16 v[20:23], v[104:107], v[56:59], v[20:23]
    s_waitcnt lgkmcnt(4)
    v_mfma_f32_16x16x32_bf16 v[20:23], v[108:111], v[60:63], v[20:23]
    s_waitcnt lgkmcnt(3)
    v_mfma_f32_16x16x32_bf16 v[20:23], v[112:115], v[64:67], v[20:23]
    v_fma_f32 v88, v16, s82, v88
    v_fma_f32 v89, v17, s82, v89
    v_fma_f32 v90, v18, s82, v90
    v_fma_f32 v91, v19, s82, v91
    v_cvt_pk_bf16_f32 v34, v88, v89
    v_cvt_pk_bf16_f32 v35, v90, v91
    s_waitcnt lgkmcnt(2)
    v_mfma_f32_16x16x32_bf16 v[20:23], v[116:119], v[68:71], v[20:23]
    s_waitcnt lgkmcnt(1)
    v_mfma_f32_16x16x32_bf16 v[20:23], v[120:123], v[72:75], v[20:23]
    s_waitcnt lgkmcnt(0)
    v_mfma_f32_16x16x32_bf16 v[20:23], v[124:127], v[76:79], v[20:23]
    s_nop 7
    v_fma_f32 v92, v20, s82, v92
    v_fma_f32 v93, v21, s82, v93
    v_fma_f32 v94, v22, s82, v94
    v_fma_f32 v95, v23, s82, v95
    v_cvt_pk_bf16_f32 v36, v92, v93
    v_cvt_pk_bf16_f32 v37, v94, v95
K_CHK:
    s_waitcnt lgkmcnt(0)
    v_readfirstlane_b32 s80, v31
    s_lshl_b32 s79, s62, 31
    s_or_b32 s80, s80, s79
    s_cmp_gt_i32 s80, 0
    s_cbranch_scc1 K_REDO
    s_cmp_ge_u32 s3, 8
    s_cbranch_scc1 K_END2
    s_add_u32 s80, s87, 4096
    s_add_u32 s79, s87, 8192
    buffer_store_dwordx2 v[32:33], v83, s[36:39], s87 offen
    buffer_store_dwordx2 v[34:35], v83, s[36:39], s80 offen
    s_mov_b64 exec, s[90:91]
    buffer_store_dwordx2 v[36:37], v83, s[36:39], s79 offen
    s_mov_b64 exec, -1
K_END2:
K_END:
    s_endpgm
K_WL:
    s_mov_b64 exec, s[4:5]
    s_cbranch_execz K_WB
    v_add_lshl_u32 v80, v80, v72, 1
    ds_write_b64 v80, v[96:97] offset:3456
    s_mov_b64 exec, s[6:7]
    s_cbranch_execz K_WB
    v_add_lshl_u32 v81, v81, v73, 1
    ds_write_b64 v81, v[98:99] offset:3456
    s_mov_b64 exec, s[8:9]
    s_cbranch_execz K_WB
    v_add_lshl_u32 v82, v82, v74, 1
    ds_write_b64 v82, v[100:101] offset:3456
    s_mov_b64 exec, s[10:11]
    s_cbranch_execz K_WB
    v_add_lshl_u32 v83, v83, v75, 1
    ds_write_b64 v83, v[102:103] offset:3456
    s_mov_b64 exec, s[12:13]
    s_cbranch_execz K_WB
    v_add_lshl_u32 v84, v84, v76, 1
    ds_write_b64 v84, v[104:105] offset:3456
    s_mov_b64 exec, s[14:15]
    s_cbranch_execz K_WB
    v_add_lshl_u32 v85, v85, v77, 1
    ds_write_b64 v85, v[106:107] offset:3456
    s_mov_b64 exec, s[16:17]
    s_cbranch_execz K_WB
    v_add_lshl_u32 v86, v86, v78, 1
    ds_write_b64 v86, v[108:109] offset:3456
    s_mov_b64 exec, s[18:19]
    s_cbranch_execz K_WB
    v_add_lshl_u32 v87, v87, v79, 1
    ds_write_b64 v87, v[110:111] offset:3456
    s_branch K_WB
K_REDO:
    s_mov_b32 s62, 1
    s_setprio 0
    v_and_b32 v36, 15, v1
    v_lshrrev_b32 v37, 4, v1
    v_mov_b32 v42, 0
    v_mov_b32 v38, 0
    s_mov_b32 s63, 1
    v_lshrrev_b32 v31, 1, v0
    v_lshlrev_b32 v31, 11, v31
    s_barrier
    s_cmp_lg_u32 s3, 0
    s_cbranch_scc1 K_RR10
    v_mov_b32 v89, 0
    ds_write_b32 v2, v89
    ds_write_b32 v89, v89 offset:256
    ds_write_b32 v89, v89 offset:880
    s_waitcnt lgkmcnt(0)
K_RR10:
    s_barrier
    s_cmp_ge_u32 s3, 8
    s_cbranch_scc1 K_B3
    s_branch K_REC0
K_SLOW:
    s_cmp_eq_u32 s63, 0
    s_cbranch_scc1 K_SL0
    v_mov_b32 v112, 0
    v_mov_b32 v113, 0
    v_mov_b32 v114, 0
    v_mov_b32 v115, 0
    v_mov_b32 v116, 0
    v_mov_b32 v117, 0
    v_mov_b32 v118, 0
    v_mov_b32 v119, 0
    v_mov_b32 v120, 0
    v_mov_b32 v121, 0
    v_mov_b32 v122, 0
    v_mov_b32 v123, 0
K_SL0:
    s_add_u32 s78, s3, 0
    v_readlane_b32 s79, v43, s78
    v_readlane_b32 s80, v44, s78
    s_mul_i32 s81, s78, 1040
    s_cmp_eq_u32 s80, 0
    s_cbranch_scc1 K_SLN0
    v_add_u32 v28, s81, v7
    ds_read_b128 v[12:15], v28
    s_lshl_b32 s79, s79, 1
    v_mov_b32 v40, s79
K_SLL0:
    ds_read_b64 v[48:49], v40 offset:3456
    v_add_u32 v40, 8, v40
    s_waitcnt lgkmcnt(0)
    v_add_u32 v48, v48, v2
    buffer_load_dword v66, v48, s[28:31], 0 offen sc1
    buffer_load_dword v67, v48, s[28:31], 0 offen offset:256 sc1
    v_pk_fma_f32 v[24:25], v[8:9], v[48:49], v[12:13] op_sel:[0,1,0]
    v_pk_fma_f32 v[26:27], v[10:11], v[48:49], v[14:15] op_sel:[0,1,0]
    s_waitcnt vmcnt(0)
    v_lshlrev_b64 v[16:17], 16, v[66:67]
    v_pk_fma_f32 v[24:25], v[66:67], s[60:61], v[24:25]
    v_pk_fma_f32 v[26:27], v[16:17], s[60:61], v[26:27]
    v_exp_f32 v32, v24
    v_exp_f32 v33, v25
    v_exp_f32 v34, v26
    v_exp_f32 v35, v27
    s_nop 0
    v_add_f32 v32, 1.0, v32
    v_add_f32 v33, 1.0, v33
    v_add_f32 v34, 1.0, v34
    v_add_f32 v35, 1.0, v35
    v_rcp_f32 v32, v32
    v_rcp_f32 v33, v33
    v_rcp_f32 v34, v34
    v_rcp_f32 v35, v35
    s_sub_u32 s80, s80, 4
    v_fmac_f32 v112, v24, v32
    v_fmac_f32 v113, v25, v33
    v_fmac_f32 v114, v26, v34
    v_fmac_f32 v115, v27, v35
    s_cmp_lg_u32 s80, 0
    s_cbranch_scc1 K_SLL0
K_SLN0:
    s_add_u32 s78, s3, 16
    v_readlane_b32 s79, v43, s78
    v_readlane_b32 s80, v44, s78
    s_mul_i32 s81, s78, 1040
    s_cmp_eq_u32 s80, 0
    s_cbranch_scc1 K_SLN1
    v_add_u32 v28, s81, v7
    ds_read_b128 v[12:15], v28
    s_lshl_b32 s79, s79, 1
    v_mov_b32 v40, s79
K_SLL1:
    ds_read_b64 v[48:49], v40 offset:3456
    v_add_u32 v40, 8, v40
    s_waitcnt lgkmcnt(0)
    v_add_u32 v48, v48, v2
    buffer_load_dword v66, v48, s[28:31], 0 offen sc1
    buffer_load_dword v67, v48, s[28:31], 0 offen offset:256 sc1
    v_pk_fma_f32 v[24:25], v[8:9], v[48:49], v[12:13] op_sel:[0,1,0]
    v_pk_fma_f32 v[26:27], v[10:11], v[48:49], v[14:15] op_sel:[0,1,0]
    s_waitcnt vmcnt(0)
    v_lshlrev_b64 v[16:17], 16, v[66:67]
    v_pk_fma_f32 v[24:25], v[66:67], s[60:61], v[24:25]
    v_pk_fma_f32 v[26:27], v[16:17], s[60:61], v[26:27]
    v_exp_f32 v32, v24
    v_exp_f32 v33, v25
    v_exp_f32 v34, v26
    v_exp_f32 v35, v27
    s_nop 0
    v_add_f32 v32, 1.0, v32
    v_add_f32 v33, 1.0, v33
    v_add_f32 v34, 1.0, v34
    v_add_f32 v35, 1.0, v35
    v_rcp_f32 v32, v32
    v_rcp_f32 v33, v33
    v_rcp_f32 v34, v34
    v_rcp_f32 v35, v35
    s_sub_u32 s80, s80, 4
    v_fmac_f32 v116, v24, v32
    v_fmac_f32 v117, v25, v33
    v_fmac_f32 v118, v26, v34
    v_fmac_f32 v119, v27, v35
    s_cmp_lg_u32 s80, 0
    s_cbranch_scc1 K_SLL1
K_SLN1:
    s_add_u32 s78, s3, 32
    v_readlane_b32 s79, v43, s78
    v_readlane_b32 s80, v44, s78
    s_mul_i32 s81, s78, 1040
    s_cmp_eq_u32 s80, 0
    s_cbranch_scc1 K_SLN2
    v_add_u32 v28, s81, v7
    ds_read_b128 v[12:15], v28
    s_lshl_b32 s79, s79, 1
    v_mov_b32 v40, s79
K_SLL2:
    ds_read_b64 v[48:49], v40 offset:3456
    v_add_u32 v40, 8, v40
    s_waitcnt lgkmcnt(0)
    v_add_u32 v48, v48, v2
    buffer_load_dword v66, v48, s[28:31], 0 offen sc1
    buffer_load_dword v67, v48, s[28:31], 0 offen offset:256 sc1
    v_pk_fma_f32 v[24:25], v[8:9], v[48:49], v[12:13] op_sel:[0,1,0]
    v_pk_fma_f32 v[26:27], v[10:11], v[48:49], v[14:15] op_sel:[0,1,0]
    s_waitcnt vmcnt(0)
    v_lshlrev_b64 v[16:17], 16, v[66:67]
    v_pk_fma_f32 v[24:25], v[66:67], s[60:61], v[24:25]
    v_pk_fma_f32 v[26:27], v[16:17], s[60:61], v[26:27]
    v_exp_f32 v32, v24
    v_exp_f32 v33, v25
    v_exp_f32 v34, v26
    v_exp_f32 v35, v27
    s_nop 0
    v_add_f32 v32, 1.0, v32
    v_add_f32 v33, 1.0, v33
    v_add_f32 v34, 1.0, v34
    v_add_f32 v35, 1.0, v35
    v_rcp_f32 v32, v32
    v_rcp_f32 v33, v33
    v_rcp_f32 v34, v34
    v_rcp_f32 v35, v35
    s_sub_u32 s80, s80, 4
    v_fmac_f32 v120, v24, v32
    v_fmac_f32 v121, v25, v33
    v_fmac_f32 v122, v26, v34
    v_fmac_f32 v123, v27, v35
    s_cmp_lg_u32 s80, 0
    s_cbranch_scc1 K_SLL2
K_SLN2:
    s_mov_b32 s63, 0
    s_waitcnt lgkmcnt(0)
    s_barrier
    s_cmp_lg_u32 s3, 0
    s_cbranch_scc1 K_RR11
    v_mov_b32 v89, 0
    ds_write_b32 v2, v89
    ds_write_b32 v89, v89 offset:256
    ds_write_b32 v89, v89 offset:880
    s_waitcnt lgkmcnt(0)
K_RR11:
    s_barrier
    s_cmp_eq_u32 s72, 0
    s_cbranch_scc1 K_SLFIN
    s_cmp_ge_u32 s3, 8
    s_cbranch_scc1 K_B3
    v_add_u32 v38, -16, v38
    v_add_u32 v39, 128, v39
    s_branch K_RECS
K_SLFIN:
    v_mov_b32 v38, 0
    v_mov_b32 v39, 0
    s_add_u32 s78, s3, 0
    s_mul_i32 s78, s78, 528
    v_add_u32 v28, s78, v4
    v_cvt_pk_bf16_f32 v24, v112, v113
    v_cvt_pk_bf16_f32 v25, v114, v115
    ds_write_b64 v28, v[24:25]
    s_add_u32 s78, s3, 16
    s_mul_i32 s78, s78, 528
    v_add_u32 v28, s78, v4
    v_cvt_pk_bf16_f32 v24, v116, v117
    v_cvt_pk_bf16_f32 v25, v118, v119
    ds_write_b64 v28, v[24:25]
    s_cmp_ge_u32 s3, 8
    s_cbranch_scc1 K_WDONE
    s_add_u32 s78, s3, 32
    s_mul_i32 s78, s78, 528
    v_add_u32 v28, s78, v4
    v_cvt_pk_bf16_f32 v24, v120, v121
    v_cvt_pk_bf16_f32 v25, v122, v123
    ds_write_b64 v28, v[24:25]
    v_lshlrev_b32 v25, 2, v36
    v_lshlrev_b32 v26, 4, v37
    v_add_u32 v35, 0, v25
    ds_bpermute_b32 v32, v35, v42
    v_add_u32 v35, 64, v25
    ds_bpermute_b32 v33, v35, v42
    v_add_u32 v35, 128, v25
    ds_bpermute_b32 v34, v35, v42
    s_lshl_b32 s78, s3, 6
    v_add_u32 v27, s78, v26
    ds_read_b128 v[92:95], v27 offset:2944
    s_movk_i32 s79, 528
    v_mad_u32_u24 v80, v36, s79, v26
    v_lshlrev_b32 v83, 8, v36
    v_lshl_add_u32 v83, v37, 3, v83
    v_add_u32 v26, 352, v26
    v_add_u32 v82, 31616, v80
    v_add_u32 v81, 23168, v80
    v_add_u32 v80, 14720, v80
    s_waitcnt lgkmcnt(0)
    v_cmp_eq_u32 vcc, 0, v32
    v_cvt_f32_u32 v32, v32
    v_mul_f32 v32, 0x3e800000, v32
    v_cndmask_b32 v80, v80, v26, vcc
    v_pk_mul_f32 v[84:85], v[92:93], v[32:33] op_sel_hi:[1,0]
    v_pk_mul_f32 v[86:87], v[94:95], v[32:33] op_sel_hi:[1,0]
    v_cmp_eq_u32 vcc, 0, v33
    v_cvt_f32_u32 v33, v33
    v_mul_f32 v33, 0x3e800000, v33
    v_cndmask_b32 v81, v81, v26, vcc
    v_pk_mul_f32 v[88:89], v[92:93], v[32:33] op_sel:[0,1]
    v_pk_mul_f32 v[90:91], v[94:95], v[32:33] op_sel:[0,1]
    v_cmp_eq_u32 vcc, 0, v34
    v_cvt_f32_u32 v34, v34
    v_mul_f32 v34, 0x3e800000, v34
    v_cndmask_b32 v82, v82, v26, vcc
    v_pk_mul_f32 v[92:93], v[92:93], v[34:35] op_sel_hi:[1,0]
    v_pk_mul_f32 v[94:95], v[94:95], v[34:35] op_sel_hi:[1,0]
    s_branch K_WDONE
K_CODE_END:
.section .rodata,"a"
.p2align 6
.amdhsa_kernel standalone__edge_featured_mpnn_mpnn__graph_kernel
  .amdhsa_next_free_vgpr 128
  .amdhsa_next_free_sgpr 102
  .amdhsa_accum_offset 128
  .amdhsa_group_segment_fixed_size 0
  .amdhsa_kernarg_size 88
  .amdhsa_user_sgpr_count 2
  .amdhsa_user_sgpr_kernarg_segment_ptr 1
  .amdhsa_system_sgpr_workgroup_id_x 1
.end_amdhsa_kernel
```
